```python
import torch

def _softmax(x, axis=-1):
    return torch.softmax(x, dim=axis)
def _gelu(x):
    return torch.nn.functional.gelu(x, approximate="tanh")
def _silu(x):
    return torch.nn.functional.silu(x)
def _sigmoid(x):
    return torch.sigmoid(x)
def _layernorm(x, axis=-1, eps=1e-5):
    m = x.mean(dim=axis, keepdim=True)
    v = x.var(dim=axis, keepdim=True, unbiased=False)
    return (x - m) / torch.sqrt(v + eps)
def _scatter_add(tgt, idx, src, axis=0):
    return tgt.clone().index_add_(axis, idx, src)
def _segment_sum(src, seg, n):
    out = torch.zeros((n,) + src.shape[1:], dtype=src.dtype)
    return out.index_add_(0, seg, src)
def _pad(x, pw):
    flat = tuple(v for pair in reversed(pw) for v in pair)
    return torch.nn.functional.pad(x, flat)

kernel_name = 'parallel_sum__spectral_fnet__dense_activation_relu__prompt'

def setup_inputs():

    _w = (lambda a: (lambda t: t.to(torch.bfloat16) if t.is_floating_point() else t)(torch.as_tensor(a)))
    def _A_setup():
        B, S, D = 1, 2048, 640
        ns = torch.arange(S)[:, None] * torch.arange(S)[None, :]
        nd = torch.arange(D)[:, None] * torch.arange(D)[None, :]
        Ws_re = torch.cos(-2.0 * torch.pi * ns / S).to(float)
        Ws_im = torch.sin(-2.0 * torch.pi * ns / S).to(float)
        Wd_re = torch.cos(-2.0 * torch.pi * nd / D).to(float)
        Wd_im = torch.sin(-2.0 * torch.pi * nd / D).to(float)
        return {
            "x": _w((lambda *s: torch.randn(*s, dtype=torch.bfloat16) * 0.05)(B, S, D)),
            "dft_seq_re": _w(Ws_re),
            "dft_seq_im": _w(Ws_im),
            "dft_hid_re": _w(Wd_re),
            "dft_hid_im": _w(Wd_im),
        }
    _A_in = _A_setup()

    def _B_setup():
        B, S, D, Dff = 1, 2048, 640, 1728
        return {
            "x": _w((lambda *s: torch.randn(*s, dtype=torch.bfloat16) * 0.05)(B, S, D)),
            "w1": _w((lambda *s: torch.randn(*s, dtype=torch.bfloat16) * 0.4)(D, Dff)),
            "w2": _w((lambda *s: torch.randn(*s, dtype=torch.bfloat16) * 0.4)(Dff, D)),
        }
    _B_in = _B_setup()

    return {
        "A_x": _A_in["x"],
        "A_dft_seq_re": _A_in["dft_seq_re"],
        "A_dft_seq_im": _A_in["dft_seq_im"],
        "A_dft_hid_re": _A_in["dft_hid_re"],
        "A_dft_hid_im": _A_in["dft_hid_im"],
        "B_x": _B_in["x"],
        "B_w1": _B_in["w1"],
        "B_w2": _B_in["w2"],
    }

def reference(A_x, A_dft_seq_re, A_dft_seq_im, A_dft_hid_re, A_dft_hid_im, B_x, B_w1, B_w2):
    def _A_ref(x, dft_seq_re, dft_seq_im, dft_hid_re, dft_hid_im):
        a = torch.einsum("bsd,ed->bse", x, dft_hid_re)
        b = torch.einsum("bsd,ed->bse", x, dft_hid_im)
        y = torch.einsum("ts,bse->bte", dft_seq_re, a) - torch.einsum("ts,bse->bte", dft_seq_im, b)
        return y

    def _B_ref(x, w1, w2):
        h = torch.einsum("bsd,df->bsf", x, w1)
        zero = torch.zeros_like(h)
        h = torch.maximum(h, zero)
        return torch.einsum("bsf,fd->bsd", h, w2)

    x = A_x
    xn = _layernorm(x, axis=-1)
    return x + _A_ref(xn, A_dft_seq_re, A_dft_seq_im, A_dft_hid_re, A_dft_hid_im) + _B_ref(xn, B_w1, B_w2)
```

```asm
; @launch grid=(256,1,1) block=(512,1,1) lds=157760
.amdgcn_target "amdgcn-amd-amdhsa--gfx950"
.text
.globl parallel_sum__spectral_fnet__dense_activation_relu__prompt_kernel
.p2align 8
.type parallel_sum__spectral_fnet__dense_activation_relu__prompt_kernel,@function
parallel_sum__spectral_fnet__dense_activation_relu__prompt_kernel:
  s_cmp_ge_u32 s2, 256
  s_cbranch_scc1 L_end
  s_load_dwordx4 s[4:7], s[0:1], 0
  s_load_dwordx4 s[8:11], s[0:1], 16
  s_load_dwordx2 s[12:13], s[0:1], 32
  s_load_dwordx4 s[64:67], s[0:1], 48
  s_load_dwordx4 s[68:71], s[0:1], 64
  s_load_dwordx2 s[16:17], s[0:1], 80
  v_lshrrev_b32 v2, 6, v0
  v_and_b32 v1, 63, v0
  s_nop 0
  v_readfirstlane_b32 s3, v2
  s_nop 3
  s_cmp_eq_u32 s3, 3
  s_cbranch_scc0 L_nocp
  s_getpc_b64 s[50:51]
J_pca:
  s_sub_u32 s50, s50, J_pca-parallel_sum__spectral_fnet__dense_activation_relu__prompt_kernel
  s_subb_u32 s51, s51, 0
  s_mov_b32 s52, ((L_code_end-parallel_sum__spectral_fnet__dense_activation_relu__prompt_kernel)>>7)-1
  s_lshr_b32 s53, s2, 3
  s_and_b32 s53, s53, 3
  s_mul_i32 s53, s53, 52
  s_mov_b32 exec_hi, 0xfffff
  v_add_u32 v22, s53, v1
  v_min_u32 v22, s52, v22
  v_lshlrev_b32 v22, 7, v22
  v_mov_b32 v23, s51
  v_add_co_u32 v22, vcc, s50, v22
  s_nop 1
  v_addc_co_u32 v23, vcc, 0, v23, vcc
  global_load_dword v127, v[22:23], off
  s_mov_b64 exec, -1
L_nocp:
  s_and_b32 s24, s2, 7
  s_lshr_b32 s25, s2, 3
  s_lshr_b32 s27, s25, 3
  s_and_b32 s28, s25, 7
  s_lshl_b32 s26, s24, 1
  s_lshr_b32 s29, s25, 4
  s_add_u32 s18, s26, s29
  s_and_b32 s19, s25, 15
  s_lshl_b32 s26, s19, 6
  s_lshl_b32 s29, s19, 7
  s_sub_u32 s29, s29, 320
  s_cmp_lt_u32 s19, 5
  s_cselect_b32 s20, s26, s29
  s_lshl_b32 s24, s24, 2
  s_add_u32 s72, s24, s27
  s_mov_b32 s73, s28
  s_mov_b32 s74, 200000
  s_getreg_b32 s77, hwreg(HW_REG_XCC_ID)
  s_and_b32 s77, s77, 15
  s_cmp_ge_u32 s3, 4
  s_cbranch_scc1 L_loader
  s_cmp_eq_u32 s3, 0
  s_cbranch_scc1 J_x_i
  s_cmp_eq_u32 s3, 1
  s_cbranch_scc1 J_c_i
  s_waitcnt lgkmcnt(0)
  s_mov_b32 s62, 12648448
  s_load_dword s75, s[16:17], s62
  s_mov_b32 s36, s16
  s_mov_b32 s37, s17
  s_mov_b32 s38, 12675072
  s_mov_b32 s39, 0x20000
  s_cmp_eq_u32 s3, 2
  s_cbranch_scc0 J_i_done
  s_mov_b32 s40, s68
  s_mov_b32 s41, s69
  s_mov_b32 s42, 2621440
  s_mov_b32 s43, 0x20000
  s_mov_b32 s44, s66
  s_mov_b32 s45, s67
  s_mov_b32 s46, 2211840
  s_mov_b32 s47, 0x20000
  v_lshlrev_b32 v22, 20, v1
  s_mov_b64 exec, 8191
  buffer_load_dword v125, v22, s[36:39], 0 offen sc1
  s_mov_b64 exec, 7
  buffer_load_dword v126, v22, s[40:43], 0 offen sc1
  buffer_load_dword v127, v22, s[44:47], 0 offen
  s_mov_b64 exec, -1
  s_branch J_i_done
J_x_i:
  s_lshr_b32 s48, s19, 2
  s_and_b32 s49, s19, 3
  s_lshl_b32 s50, s18, 1
  s_and_b32 s51, s48, 1
  s_add_u32 s50, s50, s51
  s_lshr_b32 s51, s48, 1
  s_lshl_b32 s51, s51, 5
  s_add_u32 s50, s50, s51
  s_lshl_b32 s51, s49, 9
  s_add_u32 s50, s50, s51
  s_mul_i32 s50, s50, 1280
  v_lshrrev_b32 v22, 3, v1
  s_mov_b32 s51, 81920
  v_mul_lo_u32 v22, s51, v22
  v_and_b32 v23, 7, v1
  v_lshlrev_b32 v23, 4, v23
  v_add_u32 v22, v22, v23
  v_mov_b32 v20, 157696
  v_mov_b32 v24, 0
  v_mov_b32 v25, 0
  v_mov_b32 v26, 0
  v_mov_b32 v27, 0
  ds_write_b128 v20, v[24:27]
  ds_write_b128 v20, v[24:27] offset:16
  s_waitcnt lgkmcnt(0)
  s_mov_b32 s62, 12648448
  s_load_dword s75, s[16:17], s62
  s_mov_b32 s24, s4
  s_mov_b32 s25, s5
  s_mov_b32 s26, 2621440
  s_mov_b32 s27, 0x20000
  buffer_load_dwordx4 v[32:35], v22, s[24:27], s50 offen offset:0
  buffer_load_dwordx4 v[36:39], v22, s[24:27], s50 offen offset:128
  buffer_load_dwordx4 v[40:43], v22, s[24:27], s50 offen offset:256
  buffer_load_dwordx4 v[44:47], v22, s[24:27], s50 offen offset:384
  buffer_load_dwordx4 v[48:51], v22, s[24:27], s50 offen offset:512
  buffer_load_dwordx4 v[52:55], v22, s[24:27], s50 offen offset:640
  buffer_load_dwordx4 v[56:59], v22, s[24:27], s50 offen offset:768
  buffer_load_dwordx4 v[60:63], v22, s[24:27], s50 offen offset:896
  buffer_load_dwordx4 v[64:67], v22, s[24:27], s50 offen offset:1024
  buffer_load_dwordx4 v[68:71], v22, s[24:27], s50 offen offset:1152
  s_mov_b32 s36, s16
  s_mov_b32 s37, s17
  s_mov_b32 s38, 12675072
  s_mov_b32 s39, 0x20000
  s_branch J_i_done
J_c_i:
  v_lshrrev_b32 v22, 4, v1
  v_mul_u32_u24 v22, 3456, v22
  v_and_b32 v23, 15, v1
  v_lshlrev_b32 v23, 4, v23
  v_add_u32 v22, v22, v23
  s_mul_i32 s50, s18, 138240
  s_lshl_b32 s51, s20, 1
  s_add_u32 s50, s50, s51
  s_cmp_eq_u32 s19, 0
  s_cbranch_scc0 J_c_np
  v_and_b32 v23, 7, v1
  v_lshlrev_b32 v23, 4, v23
  v_bfe_u32 v24, v1, 3, 2
  v_lshlrev_b32 v24, 15, v24
  v_add_u32 v23, v23, v24
  v_add_u32 v23, 28672, v23
  v_mov_b32 v24, 0xbf803f80
  v_mov_b32 v25, 0x3f80bf80
  v_mov_b32 v26, 0xbf803f80
  v_mov_b32 v27, 0x3f80bf80
  ds_write_b128 v23, v[24:27]
J_c_np:
  s_waitcnt lgkmcnt(0)
  s_mov_b32 s62, 12648448
  s_load_dword s75, s[16:17], s62
  s_mov_b32 s28, s64
  s_mov_b32 s29, s65
  s_mov_b32 s30, 2211840
  s_mov_b32 s31, 0x20000
  buffer_load_dwordx4 v[32:35], v22, s[28:31], s50 offen
  s_add_u32 s50, s50, 13824
  buffer_load_dwordx4 v[36:39], v22, s[28:31], s50 offen
  s_add_u32 s50, s50, 13824
  buffer_load_dwordx4 v[40:43], v22, s[28:31], s50 offen
  s_add_u32 s50, s50, 13824
  buffer_load_dwordx4 v[44:47], v22, s[28:31], s50 offen
  s_add_u32 s50, s50, 13824
  buffer_load_dwordx4 v[48:51], v22, s[28:31], s50 offen
  s_add_u32 s50, s50, 13824
  buffer_load_dwordx4 v[52:55], v22, s[28:31], s50 offen
  s_add_u32 s50, s50, 13824
  buffer_load_dwordx4 v[56:59], v22, s[28:31], s50 offen
  s_add_u32 s50, s50, 13824
  buffer_load_dwordx4 v[60:63], v22, s[28:31], s50 offen
  s_add_u32 s50, s50, 13824
  buffer_load_dwordx4 v[64:67], v22, s[28:31], s50 offen
  s_add_u32 s50, s50, 13824
  buffer_load_dwordx4 v[68:71], v22, s[28:31], s50 offen
  s_mov_b32 s36, s16
  s_mov_b32 s37, s17
  s_mov_b32 s38, 12675072
  s_mov_b32 s39, 0x20000
J_i_done:
  s_cmp_lt_u32 s19, 5
  s_cbranch_scc1 L_mx
L_hh:
  s_lshr_b32 s24, s3, 1
  s_and_b32 s25, s3, 1
  s_lshl_b32 s26, s24, 6
  v_and_b32 v20, 31, v1
  v_add_u32 v21, s26, v20
  v_lshlrev_b32 v21, 7, v21
  v_bfe_u32 v20, v1, 1, 3
  v_lshrrev_b32 v22, 5, v1
  v_xor_b32 v20, v20, v22
  v_lshlrev_b32 v20, 4, v20
  v_add_u32 v2, v21, v20
  v_xor_b32 v3, 32, v2
  v_xor_b32 v4, 64, v2
  v_xor_b32 v5, 96, v2
  v_bfe_u32 v20, v1, 5, 1
  v_lshlrev_b32 v20, 3, v20
  v_bfe_u32 v21, v1, 2, 2
  v_add_u32 v20, v20, v21
  v_lshlrev_b32 v20, 7, v20
  v_bfe_u32 v21, v1, 4, 1
  v_lshlrev_b32 v21, 1, v21
  v_bfe_u32 v22, v1, 1, 1
  v_add_u32 v21, v21, v22
  v_bfe_u32 v22, v1, 3, 1
  v_lshlrev_b32 v22, 2, v22
  v_xor_b32 v21, v21, v22
  v_lshlrev_b32 v21, 4, v21
  v_add_u32 v20, v20, v21
  v_and_b32 v21, 1, v1
  v_lshlrev_b32 v21, 3, v21
  v_add_u32 v6, v20, v21
  s_lshl_b32 s27, s25, 13
  s_add_u32 s27, s27, 16384
  v_add_u32 v6, s27, v6
  v_xor_b32 v7, 64, v6
  v_mov_b32 v128, 0
  v_mov_b32 v129, 0
  v_mov_b32 v130, 0
  v_mov_b32 v131, 0
  v_mov_b32 v132, 0
  v_mov_b32 v133, 0
  v_mov_b32 v134, 0
  v_mov_b32 v135, 0
  v_mov_b32 v136, 0
  v_mov_b32 v137, 0
  v_mov_b32 v138, 0
  v_mov_b32 v139, 0
  v_mov_b32 v140, 0
  v_mov_b32 v141, 0
  v_mov_b32 v142, 0
  v_mov_b32 v143, 0
  v_mov_b32 v144, 0
  v_mov_b32 v145, 0
  v_mov_b32 v146, 0
  v_mov_b32 v147, 0
  v_mov_b32 v148, 0
  v_mov_b32 v149, 0
  v_mov_b32 v150, 0
  v_mov_b32 v151, 0
  v_mov_b32 v152, 0
  v_mov_b32 v153, 0
  v_mov_b32 v154, 0
  v_mov_b32 v155, 0
  v_mov_b32 v156, 0
  v_mov_b32 v157, 0
  v_mov_b32 v158, 0
  v_mov_b32 v159, 0
  v_mov_b32 v160, 0
  v_mov_b32 v161, 0
  v_mov_b32 v162, 0
  v_mov_b32 v163, 0
  v_mov_b32 v164, 0
  v_mov_b32 v165, 0
  v_mov_b32 v166, 0
  v_mov_b32 v167, 0
  v_mov_b32 v168, 0
  v_mov_b32 v169, 0
  v_mov_b32 v170, 0
  v_mov_b32 v171, 0
  v_mov_b32 v172, 0
  v_mov_b32 v173, 0
  v_mov_b32 v174, 0
  v_mov_b32 v175, 0
  v_mov_b32 v176, 0
  v_mov_b32 v177, 0
  v_mov_b32 v178, 0
  v_mov_b32 v179, 0
  v_mov_b32 v180, 0
  v_mov_b32 v181, 0
  v_mov_b32 v182, 0
  v_mov_b32 v183, 0
  v_mov_b32 v184, 0
  v_mov_b32 v185, 0
  v_mov_b32 v186, 0
  v_mov_b32 v187, 0
  v_mov_b32 v188, 0
  v_mov_b32 v189, 0
  v_mov_b32 v190, 0
  v_mov_b32 v191, 0
  v_mov_b32 v8, v2
  v_mov_b32 v9, v3
  v_mov_b32 v10, v4
  v_mov_b32 v11, v5
  v_mov_b32 v12, v6
  v_mov_b32 v13, v7
  v_and_b32 v20, 31, v1
  v_add_u32 v20, s26, v20
  v_lshlrev_b32 v20, 2, v20
  v_add_u32 v20, 155648, v20
  v_lshrrev_b32 v21, 5, v1
  v_lshlrev_b32 v21, 4, v21
  s_lshl_b32 s33, s25, 8
  s_add_u32 s33, s33, 156672
  v_add_u32 v21, s33, v21
  v_bfe_u32 v26, v1, 4, 1
  v_mul_u32_u24 v26, 59392, v26
  v_lshrrev_b32 v27, 5, v1
  v_lshlrev_b32 v27, 8, v27
  v_add_u32 v26, v26, v27
  v_and_b32 v27, 15, v1
  v_lshlrev_b32 v27, 4, v27
  v_add_u32 v19, v26, v27
  s_lshl_b32 s31, s18, 3
  s_lshl_b32 s32, s24, 1
  s_add_u32 s31, s31, s32
  s_mul_i32 s31, s31, 58
  s_lshr_b32 s32, s20, 5
  s_lshl_b32 s33, s25, 1
  s_add_u32 s32, s32, s33
  s_add_u32 s31, s31, s32
  s_lshl_b32 s31, s31, 10
  s_add_u32 s31, s31, 0
  s_cmp_eq_u32 s3, 0
  s_cbranch_scc1 J_x_h
  s_cmp_eq_u32 s3, 1
  s_cbranch_scc1 J_c_h
  s_branch J_done_h
J_x_h:
  v_mov_b32 v22, 0
  v_mov_b32 v23, 0
  v_mov_b32 v24, 0
  v_mov_b32 v25, 0
  s_mov_b32 s52, 0x3f803f80
  s_waitcnt vmcnt(9)
  v_dot2_f32_bf16 v22, v32, s52, v22
  v_dot2_f32_bf16 v24, v32, v32, v24
  v_dot2_f32_bf16 v23, v33, s52, v23
  v_dot2_f32_bf16 v25, v33, v33, v25
  v_dot2_f32_bf16 v22, v34, s52, v22
  v_dot2_f32_bf16 v24, v34, v34, v24
  v_dot2_f32_bf16 v23, v35, s52, v23
  v_dot2_f32_bf16 v25, v35, v35, v25
  s_waitcnt vmcnt(8)
  v_dot2_f32_bf16 v22, v36, s52, v22
  v_dot2_f32_bf16 v24, v36, v36, v24
  v_dot2_f32_bf16 v23, v37, s52, v23
  v_dot2_f32_bf16 v25, v37, v37, v25
  v_dot2_f32_bf16 v22, v38, s52, v22
  v_dot2_f32_bf16 v24, v38, v38, v24
  v_dot2_f32_bf16 v23, v39, s52, v23
  v_dot2_f32_bf16 v25, v39, v39, v25
  s_waitcnt vmcnt(7)
  v_dot2_f32_bf16 v22, v40, s52, v22
  v_dot2_f32_bf16 v24, v40, v40, v24
  v_dot2_f32_bf16 v23, v41, s52, v23
  v_dot2_f32_bf16 v25, v41, v41, v25
  v_dot2_f32_bf16 v22, v42, s52, v22
  v_dot2_f32_bf16 v24, v42, v42, v24
  v_dot2_f32_bf16 v23, v43, s52, v23
  v_dot2_f32_bf16 v25, v43, v43, v25
  s_waitcnt vmcnt(6)
  v_dot2_f32_bf16 v22, v44, s52, v22
  v_dot2_f32_bf16 v24, v44, v44, v24
  v_dot2_f32_bf16 v23, v45, s52, v23
  v_dot2_f32_bf16 v25, v45, v45, v25
  v_dot2_f32_bf16 v22, v46, s52, v22
  v_dot2_f32_bf16 v24, v46, v46, v24
  v_dot2_f32_bf16 v23, v47, s52, v23
  v_dot2_f32_bf16 v25, v47, v47, v25
  s_waitcnt vmcnt(5)
  v_dot2_f32_bf16 v22, v48, s52, v22
  v_dot2_f32_bf16 v24, v48, v48, v24
  v_dot2_f32_bf16 v23, v49, s52, v23
  v_dot2_f32_bf16 v25, v49, v49, v25
  v_dot2_f32_bf16 v22, v50, s52, v22
  v_dot2_f32_bf16 v24, v50, v50, v24
  v_dot2_f32_bf16 v23, v51, s52, v23
  v_dot2_f32_bf16 v25, v51, v51, v25
  s_waitcnt vmcnt(4)
  v_dot2_f32_bf16 v22, v52, s52, v22
  v_dot2_f32_bf16 v24, v52, v52, v24
  v_dot2_f32_bf16 v23, v53, s52, v23
  v_dot2_f32_bf16 v25, v53, v53, v25
  v_dot2_f32_bf16 v22, v54, s52, v22
  v_dot2_f32_bf16 v24, v54, v54, v24
  v_dot2_f32_bf16 v23, v55, s52, v23
  v_dot2_f32_bf16 v25, v55, v55, v25
  s_waitcnt vmcnt(3)
  v_dot2_f32_bf16 v22, v56, s52, v22
  v_dot2_f32_bf16 v24, v56, v56, v24
  v_dot2_f32_bf16 v23, v57, s52, v23
  v_dot2_f32_bf16 v25, v57, v57, v25
  v_dot2_f32_bf16 v22, v58, s52, v22
  v_dot2_f32_bf16 v24, v58, v58, v24
  v_dot2_f32_bf16 v23, v59, s52, v23
  v_dot2_f32_bf16 v25, v59, v59, v25
  s_waitcnt vmcnt(2)
  v_dot2_f32_bf16 v22, v60, s52, v22
  v_dot2_f32_bf16 v24, v60, v60, v24
  v_dot2_f32_bf16 v23, v61, s52, v23
  v_dot2_f32_bf16 v25, v61, v61, v25
  v_dot2_f32_bf16 v22, v62, s52, v22
  v_dot2_f32_bf16 v24, v62, v62, v24
  v_dot2_f32_bf16 v23, v63, s52, v23
  v_dot2_f32_bf16 v25, v63, v63, v25
  s_waitcnt vmcnt(1)
  v_dot2_f32_bf16 v22, v64, s52, v22
  v_dot2_f32_bf16 v24, v64, v64, v24
  v_dot2_f32_bf16 v23, v65, s52, v23
  v_dot2_f32_bf16 v25, v65, v65, v25
  v_dot2_f32_bf16 v22, v66, s52, v22
  v_dot2_f32_bf16 v24, v66, v66, v24
  v_dot2_f32_bf16 v23, v67, s52, v23
  v_dot2_f32_bf16 v25, v67, v67, v25
  s_waitcnt vmcnt(0)
  v_dot2_f32_bf16 v22, v68, s52, v22
  v_dot2_f32_bf16 v24, v68, v68, v24
  v_dot2_f32_bf16 v23, v69, s52, v23
  v_dot2_f32_bf16 v25, v69, v69, v25
  v_dot2_f32_bf16 v22, v70, s52, v22
  v_dot2_f32_bf16 v24, v70, v70, v24
  v_dot2_f32_bf16 v23, v71, s52, v23
  v_dot2_f32_bf16 v25, v71, v71, v25
  s_nop 2
  v_add_f32 v22, v22, v23
  v_add_f32 v24, v24, v25
  s_nop 1
  v_add_f32_dpp v22, v22, v22 quad_perm:[1,0,3,2] row_mask:0xf bank_mask:0xf
  v_add_f32_dpp v24, v24, v24 quad_perm:[1,0,3,2] row_mask:0xf bank_mask:0xf
  s_nop 0
  v_add_f32_dpp v22, v22, v22 quad_perm:[2,3,0,1] row_mask:0xf bank_mask:0xf
  v_add_f32_dpp v24, v24, v24 quad_perm:[2,3,0,1] row_mask:0xf bank_mask:0xf
  s_nop 0
  v_add_f32_dpp v22, v22, v22 row_half_mirror row_mask:0xf bank_mask:0xf
  v_add_f32_dpp v24, v24, v24 row_half_mirror row_mask:0xf bank_mask:0xf
  s_nop 0
  s_mov_b32 s52, 0x3acccccd
  v_mul_f32 v22, s52, v22
  v_mul_f32 v24, s52, v24
  v_fma_f32 v24, -v22, v22, v24
  v_max_f32 v24, 0, v24
  v_add_f32 v24, 0x3727c5ac, v24
  v_rsq_f32 v23, v24
  s_lshl_b32 s52, s18, 10
  s_lshl_b32 s53, s19, 5
  s_add_u32 s52, s52, s53
  s_add_u32 s52, s52, 12500992
  v_lshrrev_b32 v25, 3, v1
  v_lshlrev_b32 v25, 2, v25
  v_and_b32 v26, 7, v1
  v_cmp_eq_u32 vcc, 0, v26
  s_and_saveexec_b64 s[54:55], vcc
  buffer_store_dword v22, v25, s[36:39], s52 offen sc1
  buffer_store_dword v23, v25, s[36:39], s52 offen offset:512 sc1
  s_mov_b64 exec, s[54:55]
  s_branch J_done_h
J_c_h:
  v_mov_b32 v72, 0
  v_mov_b32 v73, 0
  v_mov_b32 v74, 0
  v_mov_b32 v75, 0
  v_mov_b32 v76, 0
  v_mov_b32 v77, 0
  v_mov_b32 v78, 0
  v_mov_b32 v79, 0
  s_mov_b32 s52, 0x00003f80
  s_mov_b32 s53, 0x3f800000
  s_waitcnt vmcnt(9)
  v_dot2_f32_bf16 v72, v32, s52, v72
  v_dot2_f32_bf16 v73, v32, s53, v73
  v_dot2_f32_bf16 v74, v33, s52, v74
  v_dot2_f32_bf16 v75, v33, s53, v75
  v_dot2_f32_bf16 v76, v34, s52, v76
  v_dot2_f32_bf16 v77, v34, s53, v77
  v_dot2_f32_bf16 v78, v35, s52, v78
  v_dot2_f32_bf16 v79, v35, s53, v79
  s_waitcnt vmcnt(8)
  v_dot2_f32_bf16 v72, v36, s52, v72
  v_dot2_f32_bf16 v73, v36, s53, v73
  v_dot2_f32_bf16 v74, v37, s52, v74
  v_dot2_f32_bf16 v75, v37, s53, v75
  v_dot2_f32_bf16 v76, v38, s52, v76
  v_dot2_f32_bf16 v77, v38, s53, v77
  v_dot2_f32_bf16 v78, v39, s52, v78
  v_dot2_f32_bf16 v79, v39, s53, v79
  s_waitcnt vmcnt(7)
  v_dot2_f32_bf16 v72, v40, s52, v72
  v_dot2_f32_bf16 v73, v40, s53, v73
  v_dot2_f32_bf16 v74, v41, s52, v74
  v_dot2_f32_bf16 v75, v41, s53, v75
  v_dot2_f32_bf16 v76, v42, s52, v76
  v_dot2_f32_bf16 v77, v42, s53, v77
  v_dot2_f32_bf16 v78, v43, s52, v78
  v_dot2_f32_bf16 v79, v43, s53, v79
  s_waitcnt vmcnt(6)
  v_dot2_f32_bf16 v72, v44, s52, v72
  v_dot2_f32_bf16 v73, v44, s53, v73
  v_dot2_f32_bf16 v74, v45, s52, v74
  v_dot2_f32_bf16 v75, v45, s53, v75
  v_dot2_f32_bf16 v76, v46, s52, v76
  v_dot2_f32_bf16 v77, v46, s53, v77
  v_dot2_f32_bf16 v78, v47, s52, v78
  v_dot2_f32_bf16 v79, v47, s53, v79
  s_waitcnt vmcnt(5)
  v_dot2_f32_bf16 v72, v48, s52, v72
  v_dot2_f32_bf16 v73, v48, s53, v73
  v_dot2_f32_bf16 v74, v49, s52, v74
  v_dot2_f32_bf16 v75, v49, s53, v75
  v_dot2_f32_bf16 v76, v50, s52, v76
  v_dot2_f32_bf16 v77, v50, s53, v77
  v_dot2_f32_bf16 v78, v51, s52, v78
  v_dot2_f32_bf16 v79, v51, s53, v79
  s_waitcnt vmcnt(4)
  v_dot2_f32_bf16 v72, v52, s52, v72
  v_dot2_f32_bf16 v73, v52, s53, v73
  v_dot2_f32_bf16 v74, v53, s52, v74
  v_dot2_f32_bf16 v75, v53, s53, v75
  v_dot2_f32_bf16 v76, v54, s52, v76
  v_dot2_f32_bf16 v77, v54, s53, v77
  v_dot2_f32_bf16 v78, v55, s52, v78
  v_dot2_f32_bf16 v79, v55, s53, v79
  s_waitcnt vmcnt(3)
  v_dot2_f32_bf16 v72, v56, s52, v72
  v_dot2_f32_bf16 v73, v56, s53, v73
  v_dot2_f32_bf16 v74, v57, s52, v74
  v_dot2_f32_bf16 v75, v57, s53, v75
  v_dot2_f32_bf16 v76, v58, s52, v76
  v_dot2_f32_bf16 v77, v58, s53, v77
  v_dot2_f32_bf16 v78, v59, s52, v78
  v_dot2_f32_bf16 v79, v59, s53, v79
  s_waitcnt vmcnt(2)
  v_dot2_f32_bf16 v72, v60, s52, v72
  v_dot2_f32_bf16 v73, v60, s53, v73
  v_dot2_f32_bf16 v74, v61, s52, v74
  v_dot2_f32_bf16 v75, v61, s53, v75
  v_dot2_f32_bf16 v76, v62, s52, v76
  v_dot2_f32_bf16 v77, v62, s53, v77
  v_dot2_f32_bf16 v78, v63, s52, v78
  v_dot2_f32_bf16 v79, v63, s53, v79
  s_waitcnt vmcnt(1)
  v_dot2_f32_bf16 v72, v64, s52, v72
  v_dot2_f32_bf16 v73, v64, s53, v73
  v_dot2_f32_bf16 v74, v65, s52, v74
  v_dot2_f32_bf16 v75, v65, s53, v75
  v_dot2_f32_bf16 v76, v66, s52, v76
  v_dot2_f32_bf16 v77, v66, s53, v77
  v_dot2_f32_bf16 v78, v67, s52, v78
  v_dot2_f32_bf16 v79, v67, s53, v79
  s_waitcnt vmcnt(0)
  v_dot2_f32_bf16 v72, v68, s52, v72
  v_dot2_f32_bf16 v73, v68, s53, v73
  v_dot2_f32_bf16 v74, v69, s52, v74
  v_dot2_f32_bf16 v75, v69, s53, v75
  v_dot2_f32_bf16 v76, v70, s52, v76
  v_dot2_f32_bf16 v77, v70, s53, v77
  v_dot2_f32_bf16 v78, v71, s52, v78
  v_dot2_f32_bf16 v79, v71, s53, v79
  s_nop 2
  v_mov_b32 v80, v72
  v_mov_b32 v81, v73
  v_mov_b32 v82, v74
  v_mov_b32 v83, v75
  v_mov_b32 v84, v76
  v_mov_b32 v85, v77
  v_mov_b32 v86, v78
  v_mov_b32 v87, v79
  s_nop 0
  v_permlane16_swap_b32 v72, v80
  v_permlane16_swap_b32 v73, v81
  v_permlane16_swap_b32 v74, v82
  v_permlane16_swap_b32 v75, v83
  v_permlane16_swap_b32 v76, v84
  v_permlane16_swap_b32 v77, v85
  v_permlane16_swap_b32 v78, v86
  v_permlane16_swap_b32 v79, v87
  s_nop 0
  v_add_f32 v72, v72, v80
  v_add_f32 v73, v73, v81
  v_add_f32 v74, v74, v82
  v_add_f32 v75, v75, v83
  v_add_f32 v76, v76, v84
  v_add_f32 v77, v77, v85
  v_add_f32 v78, v78, v86
  v_add_f32 v79, v79, v87
  v_mov_b32 v80, v72
  v_mov_b32 v81, v73
  v_mov_b32 v82, v74
  v_mov_b32 v83, v75
  v_mov_b32 v84, v76
  v_mov_b32 v85, v77
  v_mov_b32 v86, v78
  v_mov_b32 v87, v79
  s_nop 0
  v_permlane32_swap_b32 v72, v80
  v_permlane32_swap_b32 v73, v81
  v_permlane32_swap_b32 v74, v82
  v_permlane32_swap_b32 v75, v83
  v_permlane32_swap_b32 v76, v84
  v_permlane32_swap_b32 v77, v85
  v_permlane32_swap_b32 v78, v86
  v_permlane32_swap_b32 v79, v87
  s_nop 0
  v_add_f32 v72, v72, v80
  v_add_f32 v73, v73, v81
  v_add_f32 v74, v74, v82
  v_add_f32 v75, v75, v83
  v_add_f32 v76, v76, v84
  v_add_f32 v77, v77, v85
  v_add_f32 v78, v78, v86
  v_add_f32 v79, v79, v87
  s_lshl_b32 s52, s18, 13
  s_lshl_b32 s53, s20, 2
  s_add_u32 s52, s52, s53
  s_add_u32 s52, s52, 12517376
  v_lshlrev_b32 v22, 5, v1
  s_mov_b32 s53, 16
  s_cmp_lt_u32 s19, 5
  s_cselect_b32 s53, 8, s53
  v_cmp_gt_u32 vcc, s53, v1
  s_and_saveexec_b64 s[54:55], vcc
  buffer_store_dwordx4 v[72:75], v22, s[36:39], s52 offen sc1
  buffer_store_dwordx4 v[76:79], v22, s[36:39], s52 offen offset:16 sc1
  s_mov_b64 exec, s[54:55]
  s_branch J_done_h
J_done_h:
  s_cmp_ge_u32 s3, 2
  s_cbranch_scc0 J_dn2_h
  s_waitcnt vmcnt(0)
J_dn2_h:
  s_waitcnt lgkmcnt(0)
  s_add_u32 s75, s75, 1
  s_xor_b32 s76, s75, 1513920225
  s_mov_b32 s48, s16
  s_mov_b32 s49, s17
  s_mov_b32 s50, 12675072
  s_mov_b32 s51, 0x20000
  s_mov_b32 s28, 0
  s_cmp_lt_u32 s3, 2
  s_cselect_b32 s30, 9, 99
  s_waitcnt lgkmcnt(0)
  s_barrier
  ds_read_b128 v[32:35], v8
  ds_read_b64_tr_b16 v[40:41], v12 offset:0
  ds_read_b64_tr_b16 v[42:43], v12 offset:512
  ds_read_b128 v[36:39], v8 offset:4096
  ds_read_b64_tr_b16 v[44:45], v13 offset:0
  ds_read_b64_tr_b16 v[46:47], v13 offset:512
  ds_read_b128 v[48:51], v9
  ds_read_b64_tr_b16 v[56:57], v12 offset:2048
  ds_read_b64_tr_b16 v[58:59], v12 offset:2560
  ds_read_b128 v[52:55], v9 offset:4096
  ds_read_b64_tr_b16 v[60:61], v13 offset:2048
  ds_read_b64_tr_b16 v[62:63], v13 offset:2560
  s_mov_b32 s29, 10
L_hh_loop:
  s_cmp_eq_u32 s29, s30
  s_cbranch_scc1 L_hh_flag1
L_hh_flag1_ret:
  s_waitcnt lgkmcnt(0)
  s_cmp_eq_u32 s29, 1
  s_cbranch_scc1 L_hh_pre
L_hh_pre_ret:
  v_mfma_f32_32x32x16_bf16 v[128:143], v[40:43], v[32:35], v[128:143]
  ds_read_b128 v[64:67], v10
  ds_read_b64_tr_b16 v[72:73], v12 offset:4096
  ds_read_b64_tr_b16 v[74:75], v12 offset:4608
  v_mfma_f32_32x32x16_bf16 v[144:159], v[40:43], v[36:39], v[144:159]
  ds_read_b128 v[68:71], v10 offset:4096
  ds_read_b64_tr_b16 v[76:77], v13 offset:4096
  ds_read_b64_tr_b16 v[78:79], v13 offset:4608
  v_mfma_f32_32x32x16_bf16 v[160:175], v[44:47], v[32:35], v[160:175]
  ds_read_b128 v[80:83], v11
  ds_read_b64_tr_b16 v[88:89], v12 offset:6144
  ds_read_b64_tr_b16 v[90:91], v12 offset:6656
  v_mfma_f32_32x32x16_bf16 v[176:191], v[44:47], v[36:39], v[176:191]
  ds_read_b128 v[84:87], v11 offset:4096
  ds_read_b64_tr_b16 v[92:93], v13 offset:6144
  ds_read_b64_tr_b16 v[94:95], v13 offset:6656
  v_mfma_f32_32x32x16_bf16 v[128:143], v[56:59], v[48:51], v[128:143]
  s_add_u32 s28, s28, 32768
  s_and_b32 s28, s28, 131071
  v_mfma_f32_32x32x16_bf16 v[144:159], v[56:59], v[52:55], v[144:159]
  v_add_u32 v8, s28, v2
  v_add_u32 v9, s28, v3
  v_add_u32 v10, s28, v4
  v_mfma_f32_32x32x16_bf16 v[160:175], v[60:63], v[48:51], v[160:175]
  v_add_u32 v11, s28, v5
  v_add_u32 v12, s28, v6
  v_add_u32 v13, s28, v7
  v_mfma_f32_32x32x16_bf16 v[176:191], v[60:63], v[52:55], v[176:191]
  s_waitcnt lgkmcnt(0)
  s_barrier
  v_mfma_f32_32x32x16_bf16 v[128:143], v[72:75], v[64:67], v[128:143]
  ds_read_b128 v[32:35], v8
  ds_read_b64_tr_b16 v[40:41], v12 offset:0
  ds_read_b64_tr_b16 v[42:43], v12 offset:512
  v_mfma_f32_32x32x16_bf16 v[144:159], v[72:75], v[68:71], v[144:159]
  ds_read_b128 v[36:39], v8 offset:4096
  ds_read_b64_tr_b16 v[44:45], v13 offset:0
  ds_read_b64_tr_b16 v[46:47], v13 offset:512
  v_mfma_f32_32x32x16_bf16 v[160:175], v[76:79], v[64:67], v[160:175]
  ds_read_b128 v[48:51], v9
  ds_read_b64_tr_b16 v[56:57], v12 offset:2048
  ds_read_b64_tr_b16 v[58:59], v12 offset:2560
  v_mfma_f32_32x32x16_bf16 v[176:191], v[76:79], v[68:71], v[176:191]
  ds_read_b128 v[52:55], v9 offset:4096
  ds_read_b64_tr_b16 v[60:61], v13 offset:2048
  ds_read_b64_tr_b16 v[62:63], v13 offset:2560
  v_mfma_f32_32x32x16_bf16 v[128:143], v[88:91], v[80:83], v[128:143]
  v_mfma_f32_32x32x16_bf16 v[144:159], v[88:91], v[84:87], v[144:159]
  v_mfma_f32_32x32x16_bf16 v[160:175], v[92:95], v[80:83], v[160:175]
  v_mfma_f32_32x32x16_bf16 v[176:191], v[92:95], v[84:87], v[176:191]
  s_sub_u32 s29, s29, 1
  s_cmp_lg_u32 s29, 0
  s_cbranch_scc1 L_hh_loop
  s_waitcnt vmcnt(0) lgkmcnt(0)
  v_readfirstlane_b32 s78, v18
  s_nop 7
  s_add_u32 s32, s31, 0
  v_pk_fma_f32 v[128:129], v[96:97], v[14:15], v[128:129] op_sel:[0,0,0] op_sel_hi:[1,0,1] neg_lo:[0,1,0] neg_hi:[0,1,0]
  v_pk_fma_f32 v[130:131], v[98:99], v[14:15], v[130:131] op_sel:[0,0,0] op_sel_hi:[1,0,1] neg_lo:[0,1,0] neg_hi:[0,1,0]
  v_pk_fma_f32 v[132:133], v[100:101], v[14:15], v[132:133] op_sel:[0,0,0] op_sel_hi:[1,0,1] neg_lo:[0,1,0] neg_hi:[0,1,0]
  v_pk_fma_f32 v[134:135], v[102:103], v[14:15], v[134:135] op_sel:[0,0,0] op_sel_hi:[1,0,1] neg_lo:[0,1,0] neg_hi:[0,1,0]
  v_pk_fma_f32 v[136:137], v[104:105], v[14:15], v[136:137] op_sel:[0,0,0] op_sel_hi:[1,0,1] neg_lo:[0,1,0] neg_hi:[0,1,0]
  v_pk_fma_f32 v[138:139], v[106:107], v[14:15], v[138:139] op_sel:[0,0,0] op_sel_hi:[1,0,1] neg_lo:[0,1,0] neg_hi:[0,1,0]
  v_pk_fma_f32 v[140:141], v[108:109], v[14:15], v[140:141] op_sel:[0,0,0] op_sel_hi:[1,0,1] neg_lo:[0,1,0] neg_hi:[0,1,0]
  v_pk_fma_f32 v[142:143], v[110:111], v[14:15], v[142:143] op_sel:[0,0,0] op_sel_hi:[1,0,1] neg_lo:[0,1,0] neg_hi:[0,1,0]
  v_pk_mul_f32 v[128:129], v[128:129], v[14:15] op_sel:[0,1] op_sel_hi:[1,1]
  v_pk_mul_f32 v[130:131], v[130:131], v[14:15] op_sel:[0,1] op_sel_hi:[1,1]
  v_pk_mul_f32 v[132:133], v[132:133], v[14:15] op_sel:[0,1] op_sel_hi:[1,1]
  v_pk_mul_f32 v[134:135], v[134:135], v[14:15] op_sel:[0,1] op_sel_hi:[1,1]
  v_pk_mul_f32 v[136:137], v[136:137], v[14:15] op_sel:[0,1] op_sel_hi:[1,1]
  v_pk_mul_f32 v[138:139], v[138:139], v[14:15] op_sel:[0,1] op_sel_hi:[1,1]
  v_pk_mul_f32 v[140:141], v[140:141], v[14:15] op_sel:[0,1] op_sel_hi:[1,1]
  v_pk_mul_f32 v[142:143], v[142:143], v[14:15] op_sel:[0,1] op_sel_hi:[1,1]
  v_cvt_pk_bf16_f32 v64, v128, v129
  v_cvt_pk_bf16_f32 v65, v130, v131
  v_cvt_pk_bf16_f32 v66, v132, v133
  v_cvt_pk_bf16_f32 v67, v134, v135
  v_cvt_pk_bf16_f32 v68, v136, v137
  v_cvt_pk_bf16_f32 v69, v138, v139
  v_cvt_pk_bf16_f32 v70, v140, v141
  v_cvt_pk_bf16_f32 v71, v142, v143
  v_pk_max_i16 v64, v64, 0
  v_pk_max_i16 v65, v65, 0
  v_pk_max_i16 v66, v66, 0
  v_pk_max_i16 v67, v67, 0
  v_pk_max_i16 v68, v68, 0
  v_pk_max_i16 v69, v69, 0
  v_pk_max_i16 v70, v70, 0
  v_pk_max_i16 v71, v71, 0
  buffer_store_dwordx4 v[64:67], v19, s[36:39], s32 offen sc1
  buffer_store_dwordx4 v[68:71], v19, s[36:39], s32 offen offset:512 sc1
  s_add_u32 s32, s31, 1024
  v_pk_fma_f32 v[160:161], v[112:113], v[14:15], v[160:161] op_sel:[0,0,0] op_sel_hi:[1,0,1] neg_lo:[0,1,0] neg_hi:[0,1,0]
  v_pk_fma_f32 v[162:163], v[114:115], v[14:15], v[162:163] op_sel:[0,0,0] op_sel_hi:[1,0,1] neg_lo:[0,1,0] neg_hi:[0,1,0]
  v_pk_fma_f32 v[164:165], v[116:117], v[14:15], v[164:165] op_sel:[0,0,0] op_sel_hi:[1,0,1] neg_lo:[0,1,0] neg_hi:[0,1,0]
  v_pk_fma_f32 v[166:167], v[118:119], v[14:15], v[166:167] op_sel:[0,0,0] op_sel_hi:[1,0,1] neg_lo:[0,1,0] neg_hi:[0,1,0]
  v_pk_fma_f32 v[168:169], v[120:121], v[14:15], v[168:169] op_sel:[0,0,0] op_sel_hi:[1,0,1] neg_lo:[0,1,0] neg_hi:[0,1,0]
  v_pk_fma_f32 v[170:171], v[122:123], v[14:15], v[170:171] op_sel:[0,0,0] op_sel_hi:[1,0,1] neg_lo:[0,1,0] neg_hi:[0,1,0]
  v_pk_fma_f32 v[172:173], v[124:125], v[14:15], v[172:173] op_sel:[0,0,0] op_sel_hi:[1,0,1] neg_lo:[0,1,0] neg_hi:[0,1,0]
  v_pk_fma_f32 v[174:175], v[126:127], v[14:15], v[174:175] op_sel:[0,0,0] op_sel_hi:[1,0,1] neg_lo:[0,1,0] neg_hi:[0,1,0]
  v_pk_mul_f32 v[160:161], v[160:161], v[14:15] op_sel:[0,1] op_sel_hi:[1,1]
  v_pk_mul_f32 v[162:163], v[162:163], v[14:15] op_sel:[0,1] op_sel_hi:[1,1]
  v_pk_mul_f32 v[164:165], v[164:165], v[14:15] op_sel:[0,1] op_sel_hi:[1,1]
  v_pk_mul_f32 v[166:167], v[166:167], v[14:15] op_sel:[0,1] op_sel_hi:[1,1]
  v_pk_mul_f32 v[168:169], v[168:169], v[14:15] op_sel:[0,1] op_sel_hi:[1,1]
  v_pk_mul_f32 v[170:171], v[170:171], v[14:15] op_sel:[0,1] op_sel_hi:[1,1]
  v_pk_mul_f32 v[172:173], v[172:173], v[14:15] op_sel:[0,1] op_sel_hi:[1,1]
  v_pk_mul_f32 v[174:175], v[174:175], v[14:15] op_sel:[0,1] op_sel_hi:[1,1]
  v_cvt_pk_bf16_f32 v72, v160, v161
  v_cvt_pk_bf16_f32 v73, v162, v163
  v_cvt_pk_bf16_f32 v74, v164, v165
  v_cvt_pk_bf16_f32 v75, v166, v167
  v_cvt_pk_bf16_f32 v76, v168, v169
  v_cvt_pk_bf16_f32 v77, v170, v171
  v_cvt_pk_bf16_f32 v78, v172, v173
  v_cvt_pk_bf16_f32 v79, v174, v175
  v_pk_max_i16 v72, v72, 0
  v_pk_max_i16 v73, v73, 0
  v_pk_max_i16 v74, v74, 0
  v_pk_max_i16 v75, v75, 0
  v_pk_max_i16 v76, v76, 0
  v_pk_max_i16 v77, v77, 0
  v_pk_max_i16 v78, v78, 0
  v_pk_max_i16 v79, v79, 0
  buffer_store_dwordx4 v[72:75], v19, s[36:39], s32 offen sc1
  buffer_store_dwordx4 v[76:79], v19, s[36:39], s32 offen offset:512 sc1
  s_add_u32 s32, s31, 237568
  v_pk_fma_f32 v[144:145], v[96:97], v[16:17], v[144:145] op_sel:[0,0,0] op_sel_hi:[1,0,1] neg_lo:[0,1,0] neg_hi:[0,1,0]
  v_pk_fma_f32 v[146:147], v[98:99], v[16:17], v[146:147] op_sel:[0,0,0] op_sel_hi:[1,0,1] neg_lo:[0,1,0] neg_hi:[0,1,0]
  v_pk_fma_f32 v[148:149], v[100:101], v[16:17], v[148:149] op_sel:[0,0,0] op_sel_hi:[1,0,1] neg_lo:[0,1,0] neg_hi:[0,1,0]
  v_pk_fma_f32 v[150:151], v[102:103], v[16:17], v[150:151] op_sel:[0,0,0] op_sel_hi:[1,0,1] neg_lo:[0,1,0] neg_hi:[0,1,0]
  v_pk_fma_f32 v[152:153], v[104:105], v[16:17], v[152:153] op_sel:[0,0,0] op_sel_hi:[1,0,1] neg_lo:[0,1,0] neg_hi:[0,1,0]
  v_pk_fma_f32 v[154:155], v[106:107], v[16:17], v[154:155] op_sel:[0,0,0] op_sel_hi:[1,0,1] neg_lo:[0,1,0] neg_hi:[0,1,0]
  v_pk_fma_f32 v[156:157], v[108:109], v[16:17], v[156:157] op_sel:[0,0,0] op_sel_hi:[1,0,1] neg_lo:[0,1,0] neg_hi:[0,1,0]
  v_pk_fma_f32 v[158:159], v[110:111], v[16:17], v[158:159] op_sel:[0,0,0] op_sel_hi:[1,0,1] neg_lo:[0,1,0] neg_hi:[0,1,0]
  v_pk_mul_f32 v[144:145], v[144:145], v[16:17] op_sel:[0,1] op_sel_hi:[1,1]
  v_pk_mul_f32 v[146:147], v[146:147], v[16:17] op_sel:[0,1] op_sel_hi:[1,1]
  v_pk_mul_f32 v[148:149], v[148:149], v[16:17] op_sel:[0,1] op_sel_hi:[1,1]
  v_pk_mul_f32 v[150:151], v[150:151], v[16:17] op_sel:[0,1] op_sel_hi:[1,1]
  v_pk_mul_f32 v[152:153], v[152:153], v[16:17] op_sel:[0,1] op_sel_hi:[1,1]
  v_pk_mul_f32 v[154:155], v[154:155], v[16:17] op_sel:[0,1] op_sel_hi:[1,1]
  v_pk_mul_f32 v[156:157], v[156:157], v[16:17] op_sel:[0,1] op_sel_hi:[1,1]
  v_pk_mul_f32 v[158:159], v[158:159], v[16:17] op_sel:[0,1] op_sel_hi:[1,1]
  v_cvt_pk_bf16_f32 v80, v144, v145
  v_cvt_pk_bf16_f32 v81, v146, v147
  v_cvt_pk_bf16_f32 v82, v148, v149
  v_cvt_pk_bf16_f32 v83, v150, v151
  v_cvt_pk_bf16_f32 v84, v152, v153
  v_cvt_pk_bf16_f32 v85, v154, v155
  v_cvt_pk_bf16_f32 v86, v156, v157
  v_cvt_pk_bf16_f32 v87, v158, v159
  v_pk_max_i16 v80, v80, 0
  v_pk_max_i16 v81, v81, 0
  v_pk_max_i16 v82, v82, 0
  v_pk_max_i16 v83, v83, 0
  v_pk_max_i16 v84, v84, 0
  v_pk_max_i16 v85, v85, 0
  v_pk_max_i16 v86, v86, 0
  v_pk_max_i16 v87, v87, 0
  buffer_store_dwordx4 v[80:83], v19, s[36:39], s32 offen sc1
  buffer_store_dwordx4 v[84:87], v19, s[36:39], s32 offen offset:512 sc1
  s_add_u32 s32, s31, 238592
  v_pk_fma_f32 v[176:177], v[112:113], v[16:17], v[176:177] op_sel:[0,0,0] op_sel_hi:[1,0,1] neg_lo:[0,1,0] neg_hi:[0,1,0]
  v_pk_fma_f32 v[178:179], v[114:115], v[16:17], v[178:179] op_sel:[0,0,0] op_sel_hi:[1,0,1] neg_lo:[0,1,0] neg_hi:[0,1,0]
  v_pk_fma_f32 v[180:181], v[116:117], v[16:17], v[180:181] op_sel:[0,0,0] op_sel_hi:[1,0,1] neg_lo:[0,1,0] neg_hi:[0,1,0]
  v_pk_fma_f32 v[182:183], v[118:119], v[16:17], v[182:183] op_sel:[0,0,0] op_sel_hi:[1,0,1] neg_lo:[0,1,0] neg_hi:[0,1,0]
  v_pk_fma_f32 v[184:185], v[120:121], v[16:17], v[184:185] op_sel:[0,0,0] op_sel_hi:[1,0,1] neg_lo:[0,1,0] neg_hi:[0,1,0]
  v_pk_fma_f32 v[186:187], v[122:123], v[16:17], v[186:187] op_sel:[0,0,0] op_sel_hi:[1,0,1] neg_lo:[0,1,0] neg_hi:[0,1,0]
  v_pk_fma_f32 v[188:189], v[124:125], v[16:17], v[188:189] op_sel:[0,0,0] op_sel_hi:[1,0,1] neg_lo:[0,1,0] neg_hi:[0,1,0]
  v_pk_fma_f32 v[190:191], v[126:127], v[16:17], v[190:191] op_sel:[0,0,0] op_sel_hi:[1,0,1] neg_lo:[0,1,0] neg_hi:[0,1,0]
  v_pk_mul_f32 v[176:177], v[176:177], v[16:17] op_sel:[0,1] op_sel_hi:[1,1]
  v_pk_mul_f32 v[178:179], v[178:179], v[16:17] op_sel:[0,1] op_sel_hi:[1,1]
  v_pk_mul_f32 v[180:181], v[180:181], v[16:17] op_sel:[0,1] op_sel_hi:[1,1]
  v_pk_mul_f32 v[182:183], v[182:183], v[16:17] op_sel:[0,1] op_sel_hi:[1,1]
  v_pk_mul_f32 v[184:185], v[184:185], v[16:17] op_sel:[0,1] op_sel_hi:[1,1]
  v_pk_mul_f32 v[186:187], v[186:187], v[16:17] op_sel:[0,1] op_sel_hi:[1,1]
  v_pk_mul_f32 v[188:189], v[188:189], v[16:17] op_sel:[0,1] op_sel_hi:[1,1]
  v_pk_mul_f32 v[190:191], v[190:191], v[16:17] op_sel:[0,1] op_sel_hi:[1,1]
  v_cvt_pk_bf16_f32 v88, v176, v177
  v_cvt_pk_bf16_f32 v89, v178, v179
  v_cvt_pk_bf16_f32 v90, v180, v181
  v_cvt_pk_bf16_f32 v91, v182, v183
  v_cvt_pk_bf16_f32 v92, v184, v185
  v_cvt_pk_bf16_f32 v93, v186, v187
  v_cvt_pk_bf16_f32 v94, v188, v189
  v_cvt_pk_bf16_f32 v95, v190, v191
  v_pk_max_i16 v88, v88, 0
  v_pk_max_i16 v89, v89, 0
  v_pk_max_i16 v90, v90, 0
  v_pk_max_i16 v91, v91, 0
  v_pk_max_i16 v92, v92, 0
  v_pk_max_i16 v93, v93, 0
  v_pk_max_i16 v94, v94, 0
  v_pk_max_i16 v95, v95, 0
  buffer_store_dwordx4 v[88:91], v19, s[36:39], s32 offen sc1
  buffer_store_dwordx4 v[92:95], v19, s[36:39], s32 offen offset:512 sc1
  s_waitcnt vmcnt(0)
  v_mov_b32 v30, 157696
  v_mov_b32 v31, 1
  s_mov_b64 exec, 1
  ds_add_rtn_u32 v31, v30, v31
  s_waitcnt lgkmcnt(0)
  s_mov_b64 exec, -1
  s_nop 0
  v_readfirstlane_b32 s63, v31
  s_nop 3
  s_cmp_eq_u32 s63, 3
  s_cbranch_scc0 L_hh_pub_np
  s_lshl_b32 s62, s18, 4
  s_add_u32 s62, s62, s19
  s_lshl_b32 s62, s62, 3
  s_add_u32 s62, s62, 12664832
  v_mov_b32 v29, s62
  s_xor_b32 s62, s76, s77
  v_mov_b32 v30, s75
  v_mov_b32 v31, s62
  s_mov_b64 exec, 1
  s_cmp_eq_u32 s78, 1
  s_cbranch_scc1 L_hh_pub_fp
  buffer_store_dwordx2 v[30:31], v29, s[48:51], 0 offen sc1
  s_branch L_hh_pub_fd
L_hh_pub_fp:
  buffer_store_dwordx2 v[30:31], v29, s[48:51], 0 offen
L_hh_pub_fd:
  s_mov_b64 exec, -1
L_hh_pub_np:
  s_endpgm
L_hh_flag1:
  s_lshl_b32 s62, s18, 4
  s_add_u32 s62, s62, s19
  s_lshl_b32 s62, s62, 3
  s_add_u32 s58, s62, 12652544
  s_lshl_b32 s62, s19, 4
  s_add_u32 s62, s62, s18
  s_lshl_b32 s62, s62, 3
  s_add_u32 s62, s62, 12654592
  s_cmp_eq_u32 s3, 1
  s_cselect_b32 s58, s62, s58
  v_mov_b32 v28, s58
  s_waitcnt vmcnt(0)
  s_xor_b32 s62, s76, s77
  v_mov_b32 v30, s75
  v_mov_b32 v31, s62
  s_mov_b64 exec, 1
  buffer_store_dwordx2 v[30:31], v28, s[48:51], 0 offen sc1
  s_mov_b64 exec, -1
  s_branch L_hh_flag1_ret
L_hh_pre:
  ds_read_b32 v14, v20
  ds_read_b32 v15, v20 offset:512
  ds_read_b32 v16, v20 offset:128
  ds_read_b32 v17, v20 offset:640
  v_mov_b32 v18, 157708
  ds_read_b32 v18, v18
  ds_read_b128 v[96:99], v21 offset:0
  ds_read_b128 v[100:103], v21 offset:32
  ds_read_b128 v[104:107], v21 offset:64
  ds_read_b128 v[108:111], v21 offset:96
  ds_read_b128 v[112:115], v21 offset:128
  ds_read_b128 v[116:119], v21 offset:160
  ds_read_b128 v[120:123], v21 offset:192
  ds_read_b128 v[124:127], v21 offset:224
  s_branch L_hh_pre_ret
L_mx:
  s_lshr_b32 s24, s3, 1
  s_and_b32 s25, s3, 1
  s_lshl_b32 s26, s3, 5
  s_xor_b32 s27, s26, 32
  v_and_b32 v24, 31, v1
  v_add_u32 v25, s26, v24
  v_lshlrev_b32 v25, 7, v25
  v_bfe_u32 v24, v1, 1, 3
  v_lshrrev_b32 v26, 5, v1
  v_xor_b32 v24, v24, v26
  v_lshlrev_b32 v24, 4, v24
  v_add_u32 v2, v25, v24
  v_xor_b32 v3, 32, v2
  v_xor_b32 v4, 64, v2
  v_xor_b32 v5, 96, v2
  v_bfe_u32 v24, v1, 5, 1
  v_lshlrev_b32 v24, 3, v24
  v_bfe_u32 v25, v1, 2, 2
  v_add_u32 v24, v24, v25
  v_lshlrev_b32 v24, 7, v24
  v_bfe_u32 v25, v1, 4, 1
  v_lshlrev_b32 v25, 1, v25
  v_bfe_u32 v26, v1, 1, 1
  v_add_u32 v25, v25, v26
  v_bfe_u32 v26, v1, 3, 1
  v_lshlrev_b32 v26, 2, v26
  v_xor_b32 v25, v25, v26
  v_lshlrev_b32 v25, 4, v25
  v_add_u32 v24, v24, v25
  v_and_b32 v25, 1, v1
  v_lshlrev_b32 v25, 3, v25
  v_add_u32 v6, v24, v25
  s_lshl_b32 s30, s25, 6
  v_xor_b32 v6, s30, v6
  v_add_u32 v6, 16384, v6
  v_mov_b32 v136, 0
  v_mov_b32 v137, 0
  v_mov_b32 v138, 0
  v_mov_b32 v139, 0
  v_mov_b32 v140, 0
  v_mov_b32 v141, 0
  v_mov_b32 v142, 0
  v_mov_b32 v143, 0
  v_mov_b32 v144, 0
  v_mov_b32 v145, 0
  v_mov_b32 v146, 0
  v_mov_b32 v147, 0
  v_mov_b32 v148, 0
  v_mov_b32 v149, 0
  v_mov_b32 v150, 0
  v_mov_b32 v151, 0
  v_mov_b32 v152, 0
  v_mov_b32 v153, 0
  v_mov_b32 v154, 0
  v_mov_b32 v155, 0
  v_mov_b32 v156, 0
  v_mov_b32 v157, 0
  v_mov_b32 v158, 0
  v_mov_b32 v159, 0
  v_mov_b32 v160, 0
  v_mov_b32 v161, 0
  v_mov_b32 v162, 0
  v_mov_b32 v163, 0
  v_mov_b32 v164, 0
  v_mov_b32 v165, 0
  v_mov_b32 v166, 0
  v_mov_b32 v167, 0
  v_mov_b32 v168, 0
  v_mov_b32 v169, 0
  v_mov_b32 v170, 0
  v_mov_b32 v171, 0
  v_mov_b32 v172, 0
  v_mov_b32 v173, 0
  v_mov_b32 v174, 0
  v_mov_b32 v175, 0
  v_mov_b32 v176, 0
  v_mov_b32 v177, 0
  v_mov_b32 v178, 0
  v_mov_b32 v179, 0
  v_mov_b32 v180, 0
  v_mov_b32 v181, 0
  v_mov_b32 v182, 0
  v_mov_b32 v183, 0
  v_mov_b32 v184, 0
  v_mov_b32 v185, 0
  v_mov_b32 v186, 0
  v_mov_b32 v187, 0
  v_mov_b32 v188, 0
  v_mov_b32 v189, 0
  v_mov_b32 v190, 0
  v_mov_b32 v191, 0
  v_mov_b32 v192, 0
  v_mov_b32 v193, 0
  v_mov_b32 v194, 0
  v_mov_b32 v195, 0
  v_mov_b32 v196, 0
  v_mov_b32 v197, 0
  v_mov_b32 v198, 0
  v_mov_b32 v199, 0
  v_mov_b32 v200, 0
  v_mov_b32 v201, 0
  v_mov_b32 v202, 0
  v_mov_b32 v203, 0
  v_mov_b32 v204, 0
  v_mov_b32 v205, 0
  v_mov_b32 v206, 0
  v_mov_b32 v207, 0
  v_mov_b32 v208, 0
  v_mov_b32 v209, 0
  v_mov_b32 v210, 0
  v_mov_b32 v211, 0
  v_mov_b32 v212, 0
  v_mov_b32 v213, 0
  v_mov_b32 v214, 0
  v_mov_b32 v215, 0
  v_mov_b32 v216, 0
  v_mov_b32 v217, 0
  v_mov_b32 v218, 0
  v_mov_b32 v219, 0
  v_mov_b32 v220, 0
  v_mov_b32 v221, 0
  v_mov_b32 v222, 0
  v_mov_b32 v223, 0
  v_mov_b32 v224, 0
  v_mov_b32 v225, 0
  v_mov_b32 v226, 0
  v_mov_b32 v227, 0
  v_mov_b32 v228, 0
  v_mov_b32 v229, 0
  v_mov_b32 v230, 0
  v_mov_b32 v231, 0
  s_lshl_b32 s31, s3, 12
  s_sub_u32 s31, 24576, s31
  s_mov_b32 s28, 0
  v_add_u32 v7, s28, v2
  v_add_u32 v8, s28, v3
  v_add_u32 v9, s28, v4
  v_add_u32 v10, s28, v5
  v_add_u32 v19, s28, v6
  v_xor_b32 v11, 0x1000, v7
  v_xor_b32 v12, 0x1000, v8
  v_xor_b32 v13, 0x1000, v9
  v_xor_b32 v14, 0x1000, v10
  v_add_u32 v15, s31, v7
  v_add_u32 v16, s31, v8
  v_add_u32 v17, s31, v9
  v_add_u32 v18, s31, v10
  s_cmp_eq_u32 s3, 0
  s_cbranch_scc1 J_x_m
  s_cmp_eq_u32 s3, 1
  s_cbranch_scc1 J_c_m
  s_branch J_done_m
J_x_m:
  v_mov_b32 v22, 0
  v_mov_b32 v23, 0
  v_mov_b32 v24, 0
  v_mov_b32 v25, 0
  s_mov_b32 s52, 0x3f803f80
  s_waitcnt vmcnt(9)
  v_dot2_f32_bf16 v22, v32, s52, v22
  v_dot2_f32_bf16 v24, v32, v32, v24
  v_dot2_f32_bf16 v23, v33, s52, v23
  v_dot2_f32_bf16 v25, v33, v33, v25
  v_dot2_f32_bf16 v22, v34, s52, v22
  v_dot2_f32_bf16 v24, v34, v34, v24
  v_dot2_f32_bf16 v23, v35, s52, v23
  v_dot2_f32_bf16 v25, v35, v35, v25
  s_waitcnt vmcnt(8)
  v_dot2_f32_bf16 v22, v36, s52, v22
  v_dot2_f32_bf16 v24, v36, v36, v24
  v_dot2_f32_bf16 v23, v37, s52, v23
  v_dot2_f32_bf16 v25, v37, v37, v25
  v_dot2_f32_bf16 v22, v38, s52, v22
  v_dot2_f32_bf16 v24, v38, v38, v24
  v_dot2_f32_bf16 v23, v39, s52, v23
  v_dot2_f32_bf16 v25, v39, v39, v25
  s_waitcnt vmcnt(7)
  v_dot2_f32_bf16 v22, v40, s52, v22
  v_dot2_f32_bf16 v24, v40, v40, v24
  v_dot2_f32_bf16 v23, v41, s52, v23
  v_dot2_f32_bf16 v25, v41, v41, v25
  v_dot2_f32_bf16 v22, v42, s52, v22
  v_dot2_f32_bf16 v24, v42, v42, v24
  v_dot2_f32_bf16 v23, v43, s52, v23
  v_dot2_f32_bf16 v25, v43, v43, v25
  s_waitcnt vmcnt(6)
  v_dot2_f32_bf16 v22, v44, s52, v22
  v_dot2_f32_bf16 v24, v44, v44, v24
  v_dot2_f32_bf16 v23, v45, s52, v23
  v_dot2_f32_bf16 v25, v45, v45, v25
  v_dot2_f32_bf16 v22, v46, s52, v22
  v_dot2_f32_bf16 v24, v46, v46, v24
  v_dot2_f32_bf16 v23, v47, s52, v23
  v_dot2_f32_bf16 v25, v47, v47, v25
  s_waitcnt vmcnt(5)
  v_dot2_f32_bf16 v22, v48, s52, v22
  v_dot2_f32_bf16 v24, v48, v48, v24
  v_dot2_f32_bf16 v23, v49, s52, v23
  v_dot2_f32_bf16 v25, v49, v49, v25
  v_dot2_f32_bf16 v22, v50, s52, v22
  v_dot2_f32_bf16 v24, v50, v50, v24
  v_dot2_f32_bf16 v23, v51, s52, v23
  v_dot2_f32_bf16 v25, v51, v51, v25
  s_waitcnt vmcnt(4)
  v_dot2_f32_bf16 v22, v52, s52, v22
  v_dot2_f32_bf16 v24, v52, v52, v24
  v_dot2_f32_bf16 v23, v53, s52, v23
  v_dot2_f32_bf16 v25, v53, v53, v25
  v_dot2_f32_bf16 v22, v54, s52, v22
  v_dot2_f32_bf16 v24, v54, v54, v24
  v_dot2_f32_bf16 v23, v55, s52, v23
  v_dot2_f32_bf16 v25, v55, v55, v25
  s_waitcnt vmcnt(3)
  v_dot2_f32_bf16 v22, v56, s52, v22
  v_dot2_f32_bf16 v24, v56, v56, v24
  v_dot2_f32_bf16 v23, v57, s52, v23
  v_dot2_f32_bf16 v25, v57, v57, v25
  v_dot2_f32_bf16 v22, v58, s52, v22
  v_dot2_f32_bf16 v24, v58, v58, v24
  v_dot2_f32_bf16 v23, v59, s52, v23
  v_dot2_f32_bf16 v25, v59, v59, v25
  s_waitcnt vmcnt(2)
  v_dot2_f32_bf16 v22, v60, s52, v22
  v_dot2_f32_bf16 v24, v60, v60, v24
  v_dot2_f32_bf16 v23, v61, s52, v23
  v_dot2_f32_bf16 v25, v61, v61, v25
  v_dot2_f32_bf16 v22, v62, s52, v22
  v_dot2_f32_bf16 v24, v62, v62, v24
  v_dot2_f32_bf16 v23, v63, s52, v23
  v_dot2_f32_bf16 v25, v63, v63, v25
  s_waitcnt vmcnt(1)
  v_dot2_f32_bf16 v22, v64, s52, v22
  v_dot2_f32_bf16 v24, v64, v64, v24
  v_dot2_f32_bf16 v23, v65, s52, v23
  v_dot2_f32_bf16 v25, v65, v65, v25
  v_dot2_f32_bf16 v22, v66, s52, v22
  v_dot2_f32_bf16 v24, v66, v66, v24
  v_dot2_f32_bf16 v23, v67, s52, v23
  v_dot2_f32_bf16 v25, v67, v67, v25
  s_waitcnt vmcnt(0)
  v_dot2_f32_bf16 v22, v68, s52, v22
  v_dot2_f32_bf16 v24, v68, v68, v24
  v_dot2_f32_bf16 v23, v69, s52, v23
  v_dot2_f32_bf16 v25, v69, v69, v25
  v_dot2_f32_bf16 v22, v70, s52, v22
  v_dot2_f32_bf16 v24, v70, v70, v24
  v_dot2_f32_bf16 v23, v71, s52, v23
  v_dot2_f32_bf16 v25, v71, v71, v25
  s_nop 2
  v_add_f32 v22, v22, v23
  v_add_f32 v24, v24, v25
  s_nop 1
  v_add_f32_dpp v22, v22, v22 quad_perm:[1,0,3,2] row_mask:0xf bank_mask:0xf
  v_add_f32_dpp v24, v24, v24 quad_perm:[1,0,3,2] row_mask:0xf bank_mask:0xf
  s_nop 0
  v_add_f32_dpp v22, v22, v22 quad_perm:[2,3,0,1] row_mask:0xf bank_mask:0xf
  v_add_f32_dpp v24, v24, v24 quad_perm:[2,3,0,1] row_mask:0xf bank_mask:0xf
  s_nop 0
  v_add_f32_dpp v22, v22, v22 row_half_mirror row_mask:0xf bank_mask:0xf
  v_add_f32_dpp v24, v24, v24 row_half_mirror row_mask:0xf bank_mask:0xf
  s_nop 0
  s_mov_b32 s52, 0x3acccccd
  v_mul_f32 v22, s52, v22
  v_mul_f32 v24, s52, v24
  v_fma_f32 v24, -v22, v22, v24
  v_max_f32 v24, 0, v24
  v_add_f32 v24, 0x3727c5ac, v24
  v_rsq_f32 v23, v24
  s_lshl_b32 s52, s18, 10
  s_lshl_b32 s53, s19, 5
  s_add_u32 s52, s52, s53
  s_add_u32 s52, s52, 12500992
  v_lshrrev_b32 v25, 3, v1
  v_lshlrev_b32 v25, 2, v25
  v_and_b32 v26, 7, v1
  v_cmp_eq_u32 vcc, 0, v26
  s_and_saveexec_b64 s[54:55], vcc
  buffer_store_dword v22, v25, s[36:39], s52 offen sc1
  buffer_store_dword v23, v25, s[36:39], s52 offen offset:512 sc1
  s_mov_b64 exec, s[54:55]
  s_branch J_done_m
J_c_m:
  v_mov_b32 v72, 0
  v_mov_b32 v73, 0
  v_mov_b32 v74, 0
  v_mov_b32 v75, 0
  v_mov_b32 v76, 0
  v_mov_b32 v77, 0
  v_mov_b32 v78, 0
  v_mov_b32 v79, 0
  s_mov_b32 s52, 0x00003f80
  s_mov_b32 s53, 0x3f800000
  s_waitcnt vmcnt(9)
  v_dot2_f32_bf16 v72, v32, s52, v72
  v_dot2_f32_bf16 v73, v32, s53, v73
  v_dot2_f32_bf16 v74, v33, s52, v74
  v_dot2_f32_bf16 v75, v33, s53, v75
  v_dot2_f32_bf16 v76, v34, s52, v76
  v_dot2_f32_bf16 v77, v34, s53, v77
  v_dot2_f32_bf16 v78, v35, s52, v78
  v_dot2_f32_bf16 v79, v35, s53, v79
  s_waitcnt vmcnt(8)
  v_dot2_f32_bf16 v72, v36, s52, v72
  v_dot2_f32_bf16 v73, v36, s53, v73
  v_dot2_f32_bf16 v74, v37, s52, v74
  v_dot2_f32_bf16 v75, v37, s53, v75
  v_dot2_f32_bf16 v76, v38, s52, v76
  v_dot2_f32_bf16 v77, v38, s53, v77
  v_dot2_f32_bf16 v78, v39, s52, v78
  v_dot2_f32_bf16 v79, v39, s53, v79
  s_waitcnt vmcnt(7)
  v_dot2_f32_bf16 v72, v40, s52, v72
  v_dot2_f32_bf16 v73, v40, s53, v73
  v_dot2_f32_bf16 v74, v41, s52, v74
  v_dot2_f32_bf16 v75, v41, s53, v75
  v_dot2_f32_bf16 v76, v42, s52, v76
  v_dot2_f32_bf16 v77, v42, s53, v77
  v_dot2_f32_bf16 v78, v43, s52, v78
  v_dot2_f32_bf16 v79, v43, s53, v79
  s_waitcnt vmcnt(6)
  v_dot2_f32_bf16 v72, v44, s52, v72
  v_dot2_f32_bf16 v73, v44, s53, v73
  v_dot2_f32_bf16 v74, v45, s52, v74
  v_dot2_f32_bf16 v75, v45, s53, v75
  v_dot2_f32_bf16 v76, v46, s52, v76
  v_dot2_f32_bf16 v77, v46, s53, v77
  v_dot2_f32_bf16 v78, v47, s52, v78
  v_dot2_f32_bf16 v79, v47, s53, v79
  s_waitcnt vmcnt(5)
  v_dot2_f32_bf16 v72, v48, s52, v72
  v_dot2_f32_bf16 v73, v48, s53, v73
  v_dot2_f32_bf16 v74, v49, s52, v74
  v_dot2_f32_bf16 v75, v49, s53, v75
  v_dot2_f32_bf16 v76, v50, s52, v76
  v_dot2_f32_bf16 v77, v50, s53, v77
  v_dot2_f32_bf16 v78, v51, s52, v78
  v_dot2_f32_bf16 v79, v51, s53, v79
  s_waitcnt vmcnt(4)
  v_dot2_f32_bf16 v72, v52, s52, v72
  v_dot2_f32_bf16 v73, v52, s53, v73
  v_dot2_f32_bf16 v74, v53, s52, v74
  v_dot2_f32_bf16 v75, v53, s53, v75
  v_dot2_f32_bf16 v76, v54, s52, v76
  v_dot2_f32_bf16 v77, v54, s53, v77
  v_dot2_f32_bf16 v78, v55, s52, v78
  v_dot2_f32_bf16 v79, v55, s53, v79
  s_waitcnt vmcnt(3)
  v_dot2_f32_bf16 v72, v56, s52, v72
  v_dot2_f32_bf16 v73, v56, s53, v73
  v_dot2_f32_bf16 v74, v57, s52, v74
  v_dot2_f32_bf16 v75, v57, s53, v75
  v_dot2_f32_bf16 v76, v58, s52, v76
  v_dot2_f32_bf16 v77, v58, s53, v77
  v_dot2_f32_bf16 v78, v59, s52, v78
  v_dot2_f32_bf16 v79, v59, s53, v79
  s_waitcnt vmcnt(2)
  v_dot2_f32_bf16 v72, v60, s52, v72
  v_dot2_f32_bf16 v73, v60, s53, v73
  v_dot2_f32_bf16 v74, v61, s52, v74
  v_dot2_f32_bf16 v75, v61, s53, v75
  v_dot2_f32_bf16 v76, v62, s52, v76
  v_dot2_f32_bf16 v77, v62, s53, v77
  v_dot2_f32_bf16 v78, v63, s52, v78
  v_dot2_f32_bf16 v79, v63, s53, v79
  s_waitcnt vmcnt(1)
  v_dot2_f32_bf16 v72, v64, s52, v72
  v_dot2_f32_bf16 v73, v64, s53, v73
  v_dot2_f32_bf16 v74, v65, s52, v74
  v_dot2_f32_bf16 v75, v65, s53, v75
  v_dot2_f32_bf16 v76, v66, s52, v76
  v_dot2_f32_bf16 v77, v66, s53, v77
  v_dot2_f32_bf16 v78, v67, s52, v78
  v_dot2_f32_bf16 v79, v67, s53, v79
  s_waitcnt vmcnt(0)
  v_dot2_f32_bf16 v72, v68, s52, v72
  v_dot2_f32_bf16 v73, v68, s53, v73
  v_dot2_f32_bf16 v74, v69, s52, v74
  v_dot2_f32_bf16 v75, v69, s53, v75
  v_dot2_f32_bf16 v76, v70, s52, v76
  v_dot2_f32_bf16 v77, v70, s53, v77
  v_dot2_f32_bf16 v78, v71, s52, v78
  v_dot2_f32_bf16 v79, v71, s53, v79
  s_nop 2
  v_mov_b32 v80, v72
  v_mov_b32 v81, v73
  v_mov_b32 v82, v74
  v_mov_b32 v83, v75
  v_mov_b32 v84, v76
  v_mov_b32 v85, v77
  v_mov_b32 v86, v78
  v_mov_b32 v87, v79
  s_nop 0
  v_permlane16_swap_b32 v72, v80
  v_permlane16_swap_b32 v73, v81
  v_permlane16_swap_b32 v74, v82
  v_permlane16_swap_b32 v75, v83
  v_permlane16_swap_b32 v76, v84
  v_permlane16_swap_b32 v77, v85
  v_permlane16_swap_b32 v78, v86
  v_permlane16_swap_b32 v79, v87
  s_nop 0
  v_add_f32 v72, v72, v80
  v_add_f32 v73, v73, v81
  v_add_f32 v74, v74, v82
  v_add_f32 v75, v75, v83
  v_add_f32 v76, v76, v84
  v_add_f32 v77, v77, v85
  v_add_f32 v78, v78, v86
  v_add_f32 v79, v79, v87
  v_mov_b32 v80, v72
  v_mov_b32 v81, v73
  v_mov_b32 v82, v74
  v_mov_b32 v83, v75
  v_mov_b32 v84, v76
  v_mov_b32 v85, v77
  v_mov_b32 v86, v78
  v_mov_b32 v87, v79
  s_nop 0
  v_permlane32_swap_b32 v72, v80
  v_permlane32_swap_b32 v73, v81
  v_permlane32_swap_b32 v74, v82
  v_permlane32_swap_b32 v75, v83
  v_permlane32_swap_b32 v76, v84
  v_permlane32_swap_b32 v77, v85
  v_permlane32_swap_b32 v78, v86
  v_permlane32_swap_b32 v79, v87
  s_nop 0
  v_add_f32 v72, v72, v80
  v_add_f32 v73, v73, v81
  v_add_f32 v74, v74, v82
  v_add_f32 v75, v75, v83
  v_add_f32 v76, v76, v84
  v_add_f32 v77, v77, v85
  v_add_f32 v78, v78, v86
  v_add_f32 v79, v79, v87
  s_lshl_b32 s52, s18, 13
  s_lshl_b32 s53, s20, 2
  s_add_u32 s52, s52, s53
  s_add_u32 s52, s52, 12517376
  v_lshlrev_b32 v22, 5, v1
  s_mov_b32 s53, 16
  s_cmp_lt_u32 s19, 5
  s_cselect_b32 s53, 8, s53
  v_cmp_gt_u32 vcc, s53, v1
  s_and_saveexec_b64 s[54:55], vcc
  buffer_store_dwordx4 v[72:75], v22, s[36:39], s52 offen sc1
  buffer_store_dwordx4 v[76:79], v22, s[36:39], s52 offen offset:16 sc1
  s_mov_b64 exec, s[54:55]
  s_branch J_done_m
J_done_m:
  s_cmp_ge_u32 s3, 2
  s_cbranch_scc0 J_dn2_m
  s_waitcnt vmcnt(0)
J_dn2_m:
  s_waitcnt lgkmcnt(0)
  s_add_u32 s75, s75, 1
  s_xor_b32 s76, s75, 1513920225
  s_mov_b32 s48, s16
  s_mov_b32 s49, s17
  s_mov_b32 s50, 12675072
  s_mov_b32 s51, 0x20000
  s_cmp_lt_u32 s3, 2
  s_cselect_b32 s30, 9, 99
  s_mov_b32 s34, 0x05040100
  s_mov_b32 s35, 0x07060302
  s_waitcnt lgkmcnt(0)
  s_barrier
  ds_read_b128 v[32:35], v7
  ds_read_b128 v[36:39], v8
  ds_read_b64_tr_b16 v[48:49], v19 offset:0
  ds_read_b64_tr_b16 v[50:51], v19 offset:512
  ds_read_b128 v[40:43], v11
  ds_read_b64_tr_b16 v[52:53], v19 offset:2048
  ds_read_b64_tr_b16 v[54:55], v19 offset:2560
  ds_read_b128 v[44:47], v12
  ds_read_b128 v[56:59], v15
  ds_read_b128 v[64:67], v15 offset:4096
  ds_read_b128 v[60:63], v16
  ds_read_b128 v[68:71], v16 offset:4096
  s_mov_b32 s29, 10
L_mx_loop:
  s_cmp_eq_u32 s29, s30
  s_cbranch_scc1 L_mx_flag1
L_mx_flag1_ret:
  s_waitcnt lgkmcnt(0)
  v_mfma_f32_32x32x16_bf16 v[136:151], v[48:51], v[32:35], v[136:151]
  v_perm_b32 v112, v33, v32, s34
  v_perm_b32 v113, v35, v34, s34
  ds_read_b128 v[72:75], v9
  ds_read_b128 v[76:79], v10
  ds_read_b64_tr_b16 v[88:89], v19 offset:4096
  v_mfma_f32_32x32x16_bf16 v[152:167], v[48:51], v[40:43], v[152:167]
  v_perm_b32 v114, v37, v36, s34
  v_perm_b32 v115, v39, v38, s34
  ds_read_b64_tr_b16 v[90:91], v19 offset:4608
  ds_read_b128 v[80:83], v13
  ds_read_b64_tr_b16 v[92:93], v19 offset:6144
  v_mfma_f32_32x32x16_bf16 v[136:151], v[52:55], v[36:39], v[136:151]
  v_perm_b32 v120, v57, v56, s34
  v_perm_b32 v121, v59, v58, s34
  ds_read_b64_tr_b16 v[94:95], v19 offset:6656
  ds_read_b128 v[84:87], v14
  ds_read_b128 v[96:99], v17
  v_mfma_f32_32x32x16_bf16 v[152:167], v[52:55], v[44:47], v[152:167]
  v_perm_b32 v122, v61, v60, s34
  v_perm_b32 v123, v63, v62, s34
  ds_read_b128 v[104:107], v17 offset:4096
  ds_read_b128 v[100:103], v18
  ds_read_b128 v[108:111], v18 offset:4096
  v_mfma_f32_32x32x16_bf16 v[168:183], v[112:115], v[120:123], v[168:183]
  v_perm_b32 v128, v65, v64, s34
  v_perm_b32 v129, v67, v66, s34
  v_perm_b32 v130, v69, v68, s34
  v_perm_b32 v131, v71, v70, s34
  v_perm_b32 v116, v33, v32, s35
  v_perm_b32 v117, v35, v34, s35
  v_mfma_f32_32x32x16_bf16 v[184:199], v[112:115], v[128:131], v[184:199]
  v_perm_b32 v118, v37, v36, s35
  v_perm_b32 v119, v39, v38, s35
  v_perm_b32 v124, v57, v56, s35
  v_perm_b32 v125, v59, v58, s35
  v_perm_b32 v126, v61, v60, s35
  v_perm_b32 v127, v63, v62, s35
  s_add_u32 s28, s28, 32768
  s_and_b32 s28, s28, 131071
  v_mfma_f32_32x32x16_bf16 v[200:215], v[116:119], v[124:127], v[200:215]
  v_perm_b32 v132, v65, v64, s35
  v_perm_b32 v133, v67, v66, s35
  v_perm_b32 v134, v69, v68, s35
  v_perm_b32 v135, v71, v70, s35
  v_add_u32 v7, s28, v2
  v_add_u32 v8, s28, v3
  v_mfma_f32_32x32x16_bf16 v[216:231], v[116:119], v[132:135], v[216:231]
  v_add_u32 v19, s28, v6
  v_xor_b32 v11, 0x1000, v7
  v_xor_b32 v12, 0x1000, v8
  v_add_u32 v15, s31, v7
  v_add_u32 v16, s31, v8
  s_waitcnt lgkmcnt(0)
  s_barrier
  v_mfma_f32_32x32x16_bf16 v[136:151], v[88:91], v[72:75], v[136:151]
  v_perm_b32 v112, v73, v72, s34
  v_perm_b32 v113, v75, v74, s34
  ds_read_b128 v[32:35], v7
  ds_read_b128 v[36:39], v8
  ds_read_b64_tr_b16 v[48:49], v19 offset:0
  v_mfma_f32_32x32x16_bf16 v[152:167], v[88:91], v[80:83], v[152:167]
  v_perm_b32 v114, v77, v76, s34
  v_perm_b32 v115, v79, v78, s34
  ds_read_b64_tr_b16 v[50:51], v19 offset:512
  ds_read_b128 v[40:43], v11
  ds_read_b64_tr_b16 v[52:53], v19 offset:2048
  v_mfma_f32_32x32x16_bf16 v[136:151], v[92:95], v[76:79], v[136:151]
  v_perm_b32 v120, v97, v96, s34
  v_perm_b32 v121, v99, v98, s34
  ds_read_b64_tr_b16 v[54:55], v19 offset:2560
  ds_read_b128 v[44:47], v12
  ds_read_b128 v[56:59], v15
  v_mfma_f32_32x32x16_bf16 v[152:167], v[92:95], v[84:87], v[152:167]
  v_perm_b32 v122, v101, v100, s34
  v_perm_b32 v123, v103, v102, s34
  ds_read_b128 v[64:67], v15 offset:4096
  ds_read_b128 v[60:63], v16
  ds_read_b128 v[68:71], v16 offset:4096
  v_mfma_f32_32x32x16_bf16 v[168:183], v[112:115], v[120:123], v[168:183]
  v_perm_b32 v128, v105, v104, s34
  v_perm_b32 v129, v107, v106, s34
  v_perm_b32 v130, v109, v108, s34
  v_perm_b32 v131, v111, v110, s34
  v_perm_b32 v116, v73, v72, s35
  v_perm_b32 v117, v75, v74, s35
  v_mfma_f32_32x32x16_bf16 v[184:199], v[112:115], v[128:131], v[184:199]
  v_perm_b32 v118, v77, v76, s35
  v_perm_b32 v119, v79, v78, s35
  v_perm_b32 v124, v97, v96, s35
  v_perm_b32 v125, v99, v98, s35
  v_perm_b32 v126, v101, v100, s35
  v_perm_b32 v127, v103, v102, s35
  v_add_u32 v9, s28, v4
  v_add_u32 v10, s28, v5
  v_mfma_f32_32x32x16_bf16 v[200:215], v[116:119], v[124:127], v[200:215]
  v_perm_b32 v132, v105, v104, s35
  v_perm_b32 v133, v107, v106, s35
  v_perm_b32 v134, v109, v108, s35
  v_perm_b32 v135, v111, v110, s35
  v_xor_b32 v13, 0x1000, v9
  v_xor_b32 v14, 0x1000, v10
  v_mfma_f32_32x32x16_bf16 v[216:231], v[116:119], v[132:135], v[216:231]
  v_add_u32 v17, s31, v9
  v_add_u32 v18, s31, v10
  s_sub_u32 s29, s29, 1
  s_cmp_lg_u32 s29, 0
  s_cbranch_scc1 L_mx_loop
  s_waitcnt vmcnt(0) lgkmcnt(0)
  v_and_b32 v24, 31, v1
  v_add_u32 v25, s26, v24
  v_lshlrev_b32 v25, 2, v25
  v_add_u32 v25, 155648, v25
  v_add_u32 v26, s27, v24
  v_lshlrev_b32 v26, 2, v26
  v_add_u32 v26, 155648, v26
  ds_read_b32 v2, v25
  ds_read_b32 v3, v25 offset:512
  ds_read_b32 v4, v26
  ds_read_b32 v5, v26 offset:512
  v_mov_b32 v7, 157708
  ds_read_b32 v7, v7
  v_lshrrev_b32 v27, 5, v1
  v_lshlrev_b32 v27, 4, v27
  s_lshl_b32 s30, s25, 7
  s_add_u32 s30, s30, 156672
  v_add_u32 v28, s30, v27
  ds_read_b128 v[32:35], v28 offset:0
  ds_read_b128 v[36:39], v28 offset:32
  ds_read_b128 v[40:43], v28 offset:64
  ds_read_b128 v[44:47], v28 offset:96
  s_lshl_b32 s30, s26, 2
  s_add_u32 s30, s30, 156160
  v_add_u32 v28, s30, v27
  ds_read_b128 v[48:51], v28 offset:0
  ds_read_b128 v[52:55], v28 offset:32
  ds_read_b128 v[56:59], v28 offset:64
  ds_read_b128 v[60:63], v28 offset:96
  v_bfe_u32 v28, v1, 4, 1
  v_mul_u32_u24 v28, 59392, v28
  v_lshrrev_b32 v29, 5, v1
  v_lshlrev_b32 v29, 8, v29
  v_add_u32 v28, v28, v29
  v_and_b32 v29, 15, v1
  v_lshlrev_b32 v29, 4, v29
  v_add_u32 v6, v28, v29
  s_lshl_b32 s31, s18, 3
  s_lshl_b32 s30, s24, 1
  s_add_u32 s31, s31, s30
  s_mul_i32 s31, s31, 58
  s_lshr_b32 s30, s20, 5
  s_add_u32 s30, s30, s25
  s_add_u32 s31, s31, s30
  s_lshl_b32 s31, s31, 10
  s_add_u32 s31, s31, 0
  s_mul_i32 s30, s25, 237568
  s_add_u32 s32, s31, s30
  s_xor_b32 s30, s25, 1
  s_mul_i32 s30, s30, 237568
  s_add_u32 s33, s31, s30
  s_waitcnt lgkmcnt(0)
  v_readfirstlane_b32 s78, v7
  s_nop 7
  v_pk_fma_f32 v[136:137], v[32:33], v[2:3], v[136:137] op_sel:[0,0,0] op_sel_hi:[1,0,1] neg_lo:[0,1,0] neg_hi:[0,1,0]
  v_pk_fma_f32 v[138:139], v[34:35], v[2:3], v[138:139] op_sel:[0,0,0] op_sel_hi:[1,0,1] neg_lo:[0,1,0] neg_hi:[0,1,0]
  v_pk_fma_f32 v[140:141], v[36:37], v[2:3], v[140:141] op_sel:[0,0,0] op_sel_hi:[1,0,1] neg_lo:[0,1,0] neg_hi:[0,1,0]
  v_pk_fma_f32 v[142:143], v[38:39], v[2:3], v[142:143] op_sel:[0,0,0] op_sel_hi:[1,0,1] neg_lo:[0,1,0] neg_hi:[0,1,0]
  v_pk_fma_f32 v[144:145], v[40:41], v[2:3], v[144:145] op_sel:[0,0,0] op_sel_hi:[1,0,1] neg_lo:[0,1,0] neg_hi:[0,1,0]
  v_pk_fma_f32 v[146:147], v[42:43], v[2:3], v[146:147] op_sel:[0,0,0] op_sel_hi:[1,0,1] neg_lo:[0,1,0] neg_hi:[0,1,0]
  v_pk_fma_f32 v[148:149], v[44:45], v[2:3], v[148:149] op_sel:[0,0,0] op_sel_hi:[1,0,1] neg_lo:[0,1,0] neg_hi:[0,1,0]
  v_pk_fma_f32 v[150:151], v[46:47], v[2:3], v[150:151] op_sel:[0,0,0] op_sel_hi:[1,0,1] neg_lo:[0,1,0] neg_hi:[0,1,0]
  v_pk_mul_f32 v[136:137], v[136:137], v[2:3] op_sel:[0,1] op_sel_hi:[1,1]
  v_pk_mul_f32 v[138:139], v[138:139], v[2:3] op_sel:[0,1] op_sel_hi:[1,1]
  v_pk_mul_f32 v[140:141], v[140:141], v[2:3] op_sel:[0,1] op_sel_hi:[1,1]
  v_pk_mul_f32 v[142:143], v[142:143], v[2:3] op_sel:[0,1] op_sel_hi:[1,1]
  v_pk_mul_f32 v[144:145], v[144:145], v[2:3] op_sel:[0,1] op_sel_hi:[1,1]
  v_pk_mul_f32 v[146:147], v[146:147], v[2:3] op_sel:[0,1] op_sel_hi:[1,1]
  v_pk_mul_f32 v[148:149], v[148:149], v[2:3] op_sel:[0,1] op_sel_hi:[1,1]
  v_pk_mul_f32 v[150:151], v[150:151], v[2:3] op_sel:[0,1] op_sel_hi:[1,1]
  v_cvt_pk_bf16_f32 v64, v136, v137
  v_cvt_pk_bf16_f32 v65, v138, v139
  v_cvt_pk_bf16_f32 v66, v140, v141
  v_cvt_pk_bf16_f32 v67, v142, v143
  v_cvt_pk_bf16_f32 v68, v144, v145
  v_cvt_pk_bf16_f32 v69, v146, v147
  v_cvt_pk_bf16_f32 v70, v148, v149
  v_cvt_pk_bf16_f32 v71, v150, v151
  v_pk_max_i16 v64, v64, 0
  v_pk_max_i16 v65, v65, 0
  v_pk_max_i16 v66, v66, 0
  v_pk_max_i16 v67, v67, 0
  v_pk_max_i16 v68, v68, 0
  v_pk_max_i16 v69, v69, 0
  v_pk_max_i16 v70, v70, 0
  v_pk_max_i16 v71, v71, 0
  buffer_store_dwordx4 v[64:67], v6, s[36:39], s32 offen sc1
  buffer_store_dwordx4 v[68:71], v6, s[36:39], s32 offen offset:512 sc1
  v_pk_fma_f32 v[152:153], v[32:33], v[4:5], v[152:153] op_sel:[0,0,0] op_sel_hi:[1,0,1] neg_lo:[0,1,0] neg_hi:[0,1,0]
  v_pk_fma_f32 v[154:155], v[34:35], v[4:5], v[154:155] op_sel:[0,0,0] op_sel_hi:[1,0,1] neg_lo:[0,1,0] neg_hi:[0,1,0]
  v_pk_fma_f32 v[156:157], v[36:37], v[4:5], v[156:157] op_sel:[0,0,0] op_sel_hi:[1,0,1] neg_lo:[0,1,0] neg_hi:[0,1,0]
  v_pk_fma_f32 v[158:159], v[38:39], v[4:5], v[158:159] op_sel:[0,0,0] op_sel_hi:[1,0,1] neg_lo:[0,1,0] neg_hi:[0,1,0]
  v_pk_fma_f32 v[160:161], v[40:41], v[4:5], v[160:161] op_sel:[0,0,0] op_sel_hi:[1,0,1] neg_lo:[0,1,0] neg_hi:[0,1,0]
  v_pk_fma_f32 v[162:163], v[42:43], v[4:5], v[162:163] op_sel:[0,0,0] op_sel_hi:[1,0,1] neg_lo:[0,1,0] neg_hi:[0,1,0]
  v_pk_fma_f32 v[164:165], v[44:45], v[4:5], v[164:165] op_sel:[0,0,0] op_sel_hi:[1,0,1] neg_lo:[0,1,0] neg_hi:[0,1,0]
  v_pk_fma_f32 v[166:167], v[46:47], v[4:5], v[166:167] op_sel:[0,0,0] op_sel_hi:[1,0,1] neg_lo:[0,1,0] neg_hi:[0,1,0]
  v_pk_mul_f32 v[152:153], v[152:153], v[4:5] op_sel:[0,1] op_sel_hi:[1,1]
  v_pk_mul_f32 v[154:155], v[154:155], v[4:5] op_sel:[0,1] op_sel_hi:[1,1]
  v_pk_mul_f32 v[156:157], v[156:157], v[4:5] op_sel:[0,1] op_sel_hi:[1,1]
  v_pk_mul_f32 v[158:159], v[158:159], v[4:5] op_sel:[0,1] op_sel_hi:[1,1]
  v_pk_mul_f32 v[160:161], v[160:161], v[4:5] op_sel:[0,1] op_sel_hi:[1,1]
  v_pk_mul_f32 v[162:163], v[162:163], v[4:5] op_sel:[0,1] op_sel_hi:[1,1]
  v_pk_mul_f32 v[164:165], v[164:165], v[4:5] op_sel:[0,1] op_sel_hi:[1,1]
  v_pk_mul_f32 v[166:167], v[166:167], v[4:5] op_sel:[0,1] op_sel_hi:[1,1]
  v_cvt_pk_bf16_f32 v72, v152, v153
  v_cvt_pk_bf16_f32 v73, v154, v155
  v_cvt_pk_bf16_f32 v74, v156, v157
  v_cvt_pk_bf16_f32 v75, v158, v159
  v_cvt_pk_bf16_f32 v76, v160, v161
  v_cvt_pk_bf16_f32 v77, v162, v163
  v_cvt_pk_bf16_f32 v78, v164, v165
  v_cvt_pk_bf16_f32 v79, v166, v167
  v_pk_max_i16 v72, v72, 0
  v_pk_max_i16 v73, v73, 0
  v_pk_max_i16 v74, v74, 0
  v_pk_max_i16 v75, v75, 0
  v_pk_max_i16 v76, v76, 0
  v_pk_max_i16 v77, v77, 0
  v_pk_max_i16 v78, v78, 0
  v_pk_max_i16 v79, v79, 0
  buffer_store_dwordx4 v[72:75], v6, s[36:39], s33 offen sc1
  buffer_store_dwordx4 v[76:79], v6, s[36:39], s33 offen offset:512 sc1
  v_and_b32 v24, 31, v1
  v_cvt_f32_u32 v24, v24
  v_lshrrev_b32 v25, 5, v1
  v_cvt_f32_u32 v25, v25
  v_mul_f32 v25, 0x3e000000, v25
  v_mul_f32 v25, v25, v24
  v_fmamk_f32 v26, v24, 0x0, v25
  v_fract_f32 v26, v26
  v_cos_f32 v28, v26
  v_sin_f32 v30, v26
  v_fmamk_f32 v26, v24, 0x3d000000, v25
  v_fract_f32 v26, v26
  v_cos_f32 v29, v26
  v_sin_f32 v31, v26
  s_nop 0
  v_cvt_pk_bf16_f32 v232, v28, v29
  v_cvt_pk_bf16_f32 v248, v30, v31
  v_fmamk_f32 v26, v24, 0x3d800000, v25
  v_fract_f32 v26, v26
  v_cos_f32 v28, v26
  v_sin_f32 v30, v26
  v_fmamk_f32 v26, v24, 0x3dc00000, v25
  v_fract_f32 v26, v26
  v_cos_f32 v29, v26
  v_sin_f32 v31, v26
  s_nop 0
  v_cvt_pk_bf16_f32 v233, v28, v29
  v_cvt_pk_bf16_f32 v249, v30, v31
  v_fmamk_f32 v26, v24, 0x3e800000, v25
  v_fract_f32 v26, v26
  v_cos_f32 v28, v26
  v_sin_f32 v30, v26
  v_fmamk_f32 v26, v24, 0x3e900000, v25
  v_fract_f32 v26, v26
  v_cos_f32 v29, v26
  v_sin_f32 v31, v26
  s_nop 0
  v_cvt_pk_bf16_f32 v234, v28, v29
  v_cvt_pk_bf16_f32 v250, v30, v31
  v_fmamk_f32 v26, v24, 0x3ea00000, v25
  v_fract_f32 v26, v26
  v_cos_f32 v28, v26
  v_sin_f32 v30, v26
  v_fmamk_f32 v26, v24, 0x3eb00000, v25
  v_fract_f32 v26, v26
  v_cos_f32 v29, v26
  v_sin_f32 v31, v26
  s_nop 0
  v_cvt_pk_bf16_f32 v235, v28, v29
  v_cvt_pk_bf16_f32 v251, v30, v31
  v_fmamk_f32 v26, v24, 0x3f000000, v25
  v_fract_f32 v26, v26
  v_cos_f32 v28, v26
  v_sin_f32 v30, v26
  v_fmamk_f32 v26, v24, 0x3f080000, v25
  v_fract_f32 v26, v26
  v_cos_f32 v29, v26
  v_sin_f32 v31, v26
  s_nop 0
  v_cvt_pk_bf16_f32 v236, v28, v29
  v_cvt_pk_bf16_f32 v252, v30, v31
  v_fmamk_f32 v26, v24, 0x3f100000, v25
  v_fract_f32 v26, v26
  v_cos_f32 v28, v26
  v_sin_f32 v30, v26
  v_fmamk_f32 v26, v24, 0x3f180000, v25
  v_fract_f32 v26, v26
  v_cos_f32 v29, v26
  v_sin_f32 v31, v26
  s_nop 0
  v_cvt_pk_bf16_f32 v237, v28, v29
  v_cvt_pk_bf16_f32 v253, v30, v31
  v_fmamk_f32 v26, v24, 0x3f400000, v25
  v_fract_f32 v26, v26
  v_cos_f32 v28, v26
  v_sin_f32 v30, v26
  v_fmamk_f32 v26, v24, 0x3f480000, v25
  v_fract_f32 v26, v26
  v_cos_f32 v29, v26
  v_sin_f32 v31, v26
  s_nop 0
  v_cvt_pk_bf16_f32 v238, v28, v29
  v_cvt_pk_bf16_f32 v254, v30, v31
  v_fmamk_f32 v26, v24, 0x3f500000, v25
  v_fract_f32 v26, v26
  v_cos_f32 v28, v26
  v_sin_f32 v30, v26
  v_fmamk_f32 v26, v24, 0x3f580000, v25
  v_fract_f32 v26, v26
  v_cos_f32 v29, v26
  v_sin_f32 v31, v26
  s_nop 0
  v_cvt_pk_bf16_f32 v239, v28, v29
  v_cvt_pk_bf16_f32 v255, v30, v31
  v_xor_b32 v240, 0x80008000, v248
  v_xor_b32 v241, 0x80008000, v249
  v_xor_b32 v242, 0x80008000, v250
  v_xor_b32 v243, 0x80008000, v251
  v_xor_b32 v244, 0x80008000, v252
  v_xor_b32 v245, 0x80008000, v253
  v_xor_b32 v246, 0x80008000, v254
  v_xor_b32 v247, 0x80008000, v255
  v_pk_mul_f32 v[168:169], v[168:169], v[48:49]
  v_pk_mul_f32 v[200:201], v[200:201], v[48:49]
  v_pk_mul_f32 v[184:185], v[184:185], v[48:49]
  v_pk_mul_f32 v[216:217], v[216:217], v[48:49]
  v_pk_mul_f32 v[170:171], v[170:171], v[50:51]
  v_pk_mul_f32 v[202:203], v[202:203], v[50:51]
  v_pk_mul_f32 v[186:187], v[186:187], v[50:51]
  v_pk_mul_f32 v[218:219], v[218:219], v[50:51]
  v_pk_mul_f32 v[172:173], v[172:173], v[52:53]
  v_pk_mul_f32 v[204:205], v[204:205], v[52:53]
  v_pk_mul_f32 v[188:189], v[188:189], v[52:53]
  v_pk_mul_f32 v[220:221], v[220:221], v[52:53]
  v_pk_mul_f32 v[174:175], v[174:175], v[54:55]
  v_pk_mul_f32 v[206:207], v[206:207], v[54:55]
  v_pk_mul_f32 v[190:191], v[190:191], v[54:55]
  v_pk_mul_f32 v[222:223], v[222:223], v[54:55]
  v_pk_mul_f32 v[176:177], v[176:177], v[56:57]
  v_pk_mul_f32 v[208:209], v[208:209], v[56:57]
  v_pk_mul_f32 v[192:193], v[192:193], v[56:57]
  v_pk_mul_f32 v[224:225], v[224:225], v[56:57]
  v_pk_mul_f32 v[178:179], v[178:179], v[58:59]
  v_pk_mul_f32 v[210:211], v[210:211], v[58:59]
  v_pk_mul_f32 v[194:195], v[194:195], v[58:59]
  v_pk_mul_f32 v[226:227], v[226:227], v[58:59]
  v_pk_mul_f32 v[180:181], v[180:181], v[60:61]
  v_pk_mul_f32 v[212:213], v[212:213], v[60:61]
  v_pk_mul_f32 v[196:197], v[196:197], v[60:61]
  v_pk_mul_f32 v[228:229], v[228:229], v[60:61]
  v_pk_mul_f32 v[182:183], v[182:183], v[62:63]
  v_pk_mul_f32 v[214:215], v[214:215], v[62:63]
  v_pk_mul_f32 v[198:199], v[198:199], v[62:63]
  v_pk_mul_f32 v[230:231], v[230:231], v[62:63]
  v_pk_add_f32 v[80:81], v[168:169], v[200:201]
  v_pk_add_f32 v[168:169], v[168:169], v[200:201] neg_lo:[0,1] neg_hi:[0,1]
  v_pk_add_f32 v[96:97], v[184:185], v[216:217]
  v_pk_add_f32 v[200:201], v[216:217], v[184:185] neg_lo:[0,1] neg_hi:[0,1]
  v_pk_add_f32 v[82:83], v[170:171], v[202:203]
  v_pk_add_f32 v[170:171], v[170:171], v[202:203] neg_lo:[0,1] neg_hi:[0,1]
  v_pk_add_f32 v[98:99], v[186:187], v[218:219]
  v_pk_add_f32 v[202:203], v[218:219], v[186:187] neg_lo:[0,1] neg_hi:[0,1]
  v_pk_add_f32 v[84:85], v[172:173], v[204:205]
  v_pk_add_f32 v[172:173], v[172:173], v[204:205] neg_lo:[0,1] neg_hi:[0,1]
  v_pk_add_f32 v[100:101], v[188:189], v[220:221]
  v_pk_add_f32 v[204:205], v[220:221], v[188:189] neg_lo:[0,1] neg_hi:[0,1]
  v_pk_add_f32 v[86:87], v[174:175], v[206:207]
  v_pk_add_f32 v[174:175], v[174:175], v[206:207] neg_lo:[0,1] neg_hi:[0,1]
  v_pk_add_f32 v[102:103], v[190:191], v[222:223]
  v_pk_add_f32 v[206:207], v[222:223], v[190:191] neg_lo:[0,1] neg_hi:[0,1]
  v_pk_add_f32 v[88:89], v[176:177], v[208:209]
  v_pk_add_f32 v[176:177], v[176:177], v[208:209] neg_lo:[0,1] neg_hi:[0,1]
  v_pk_add_f32 v[104:105], v[192:193], v[224:225]
  v_pk_add_f32 v[208:209], v[224:225], v[192:193] neg_lo:[0,1] neg_hi:[0,1]
  v_pk_add_f32 v[90:91], v[178:179], v[210:211]
  v_pk_add_f32 v[178:179], v[178:179], v[210:211] neg_lo:[0,1] neg_hi:[0,1]
  v_pk_add_f32 v[106:107], v[194:195], v[226:227]
  v_pk_add_f32 v[210:211], v[226:227], v[194:195] neg_lo:[0,1] neg_hi:[0,1]
  v_pk_add_f32 v[92:93], v[180:181], v[212:213]
  v_pk_add_f32 v[180:181], v[180:181], v[212:213] neg_lo:[0,1] neg_hi:[0,1]
  v_pk_add_f32 v[108:109], v[196:197], v[228:229]
  v_pk_add_f32 v[212:213], v[228:229], v[196:197] neg_lo:[0,1] neg_hi:[0,1]
  v_pk_add_f32 v[94:95], v[182:183], v[214:215]
  v_pk_add_f32 v[182:183], v[182:183], v[214:215] neg_lo:[0,1] neg_hi:[0,1]
  v_pk_add_f32 v[110:111], v[198:199], v[230:231]
  v_pk_add_f32 v[214:215], v[230:231], v[198:199] neg_lo:[0,1] neg_hi:[0,1]
  v_and_b32 v24, 31, v1
  v_cmp_eq_u32 s[40:41], 0, v24
  s_nop 3
  s_cmp_eq_u32 s19, 0
  s_cselect_b64 s[40:41], s[40:41], 0
  s_cbranch_scc0 L_mx_nofix
  v_cndmask_b32 v80, v80, v184, s[40:41]
  v_cndmask_b32 v96, v96, v216, s[40:41]
  v_cndmask_b32_e64 v200, v200, 0, s[40:41]
  v_cndmask_b32 v81, v81, v185, s[40:41]
  v_cndmask_b32 v97, v97, v217, s[40:41]
  v_cndmask_b32_e64 v201, v201, 0, s[40:41]
  v_cndmask_b32 v82, v82, v186, s[40:41]
  v_cndmask_b32 v98, v98, v218, s[40:41]
  v_cndmask_b32_e64 v202, v202, 0, s[40:41]
  v_cndmask_b32 v83, v83, v187, s[40:41]
  v_cndmask_b32 v99, v99, v219, s[40:41]
  v_cndmask_b32_e64 v203, v203, 0, s[40:41]
  v_cndmask_b32 v84, v84, v188, s[40:41]
  v_cndmask_b32 v100, v100, v220, s[40:41]
  v_cndmask_b32_e64 v204, v204, 0, s[40:41]
  v_cndmask_b32 v85, v85, v189, s[40:41]
  v_cndmask_b32 v101, v101, v221, s[40:41]
  v_cndmask_b32_e64 v205, v205, 0, s[40:41]
  v_cndmask_b32 v86, v86, v190, s[40:41]
  v_cndmask_b32 v102, v102, v222, s[40:41]
  v_cndmask_b32_e64 v206, v206, 0, s[40:41]
  v_cndmask_b32 v87, v87, v191, s[40:41]
  v_cndmask_b32 v103, v103, v223, s[40:41]
  v_cndmask_b32_e64 v207, v207, 0, s[40:41]
  v_cndmask_b32 v88, v88, v192, s[40:41]
  v_cndmask_b32 v104, v104, v224, s[40:41]
  v_cndmask_b32_e64 v208, v208, 0, s[40:41]
  v_cndmask_b32 v89, v89, v193, s[40:41]
  v_cndmask_b32 v105, v105, v225, s[40:41]
  v_cndmask_b32_e64 v209, v209, 0, s[40:41]
  v_cndmask_b32 v90, v90, v194, s[40:41]
  v_cndmask_b32 v106, v106, v226, s[40:41]
  v_cndmask_b32_e64 v210, v210, 0, s[40:41]
  v_cndmask_b32 v91, v91, v195, s[40:41]
  v_cndmask_b32 v107, v107, v227, s[40:41]
  v_cndmask_b32_e64 v211, v211, 0, s[40:41]
  v_cndmask_b32 v92, v92, v196, s[40:41]
  v_cndmask_b32 v108, v108, v228, s[40:41]
  v_cndmask_b32_e64 v212, v212, 0, s[40:41]
  v_cndmask_b32 v93, v93, v197, s[40:41]
  v_cndmask_b32 v109, v109, v229, s[40:41]
  v_cndmask_b32_e64 v213, v213, 0, s[40:41]
  v_cndmask_b32 v94, v94, v198, s[40:41]
  v_cndmask_b32 v110, v110, v230, s[40:41]
  v_cndmask_b32_e64 v214, v214, 0, s[40:41]
  v_cndmask_b32 v95, v95, v199, s[40:41]
  v_cndmask_b32 v111, v111, v231, s[40:41]
  v_cndmask_b32_e64 v215, v215, 0, s[40:41]
L_mx_nofix:
  v_cvt_pk_bf16_f32 v32, v80, v81
  v_cvt_pk_bf16_f32 v33, v82, v83
  v_cvt_pk_bf16_f32 v34, v84, v85
  v_cvt_pk_bf16_f32 v35, v86, v87
  v_cvt_pk_bf16_f32 v36, v88, v89
  v_cvt_pk_bf16_f32 v37, v90, v91
  v_cvt_pk_bf16_f32 v38, v92, v93
  v_cvt_pk_bf16_f32 v39, v94, v95
  v_cvt_pk_bf16_f32 v40, v96, v97
  v_cvt_pk_bf16_f32 v41, v98, v99
  v_cvt_pk_bf16_f32 v42, v100, v101
  v_cvt_pk_bf16_f32 v43, v102, v103
  v_cvt_pk_bf16_f32 v44, v104, v105
  v_cvt_pk_bf16_f32 v45, v106, v107
  v_cvt_pk_bf16_f32 v46, v108, v109
  v_cvt_pk_bf16_f32 v47, v110, v111
  v_cvt_pk_bf16_f32 v48, v168, v169
  v_cvt_pk_bf16_f32 v49, v170, v171
  v_cvt_pk_bf16_f32 v50, v172, v173
  v_cvt_pk_bf16_f32 v51, v174, v175
  v_cvt_pk_bf16_f32 v52, v176, v177
  v_cvt_pk_bf16_f32 v53, v178, v179
  v_cvt_pk_bf16_f32 v54, v180, v181
  v_cvt_pk_bf16_f32 v55, v182, v183
  v_cvt_pk_bf16_f32 v56, v200, v201
  v_cvt_pk_bf16_f32 v57, v202, v203
  v_cvt_pk_bf16_f32 v58, v204, v205
  v_cvt_pk_bf16_f32 v59, v206, v207
  v_cvt_pk_bf16_f32 v60, v208, v209
  v_cvt_pk_bf16_f32 v61, v210, v211
  v_cvt_pk_bf16_f32 v62, v212, v213
  v_cvt_pk_bf16_f32 v63, v214, v215
  s_nop 1
  v_mfma_f32_32x32x16_bf16 v[168:183], v[232:235], v[32:35], 0
  v_mfma_f32_32x32x16_bf16 v[184:199], v[232:235], v[40:43], 0
  v_mfma_f32_32x32x16_bf16 v[168:183], v[236:239], v[36:39], v[168:183]
  v_mfma_f32_32x32x16_bf16 v[184:199], v[236:239], v[44:47], v[184:199]
  v_mfma_f32_32x32x16_bf16 v[168:183], v[248:251], v[40:43], v[168:183]
  v_mfma_f32_32x32x16_bf16 v[184:199], v[240:243], v[32:35], v[184:199]
  v_mfma_f32_32x32x16_bf16 v[168:183], v[252:255], v[44:47], v[168:183]
  v_mfma_f32_32x32x16_bf16 v[184:199], v[244:247], v[36:39], v[184:199]
  v_mfma_f32_32x32x16_bf16 v[200:215], v[232:235], v[48:51], 0
  v_mfma_f32_32x32x16_bf16 v[216:231], v[232:235], v[56:59], 0
  v_mfma_f32_32x32x16_bf16 v[200:215], v[236:239], v[52:55], v[200:215]
  v_mfma_f32_32x32x16_bf16 v[216:231], v[236:239], v[60:63], v[216:231]
  v_mfma_f32_32x32x16_bf16 v[200:215], v[248:251], v[56:59], v[200:215]
  v_mfma_f32_32x32x16_bf16 v[216:231], v[240:243], v[48:51], v[216:231]
  v_mfma_f32_32x32x16_bf16 v[200:215], v[252:255], v[60:63], v[200:215]
  v_mfma_f32_32x32x16_bf16 v[216:231], v[244:247], v[52:55], v[216:231]
  s_waitcnt vmcnt(0)
  v_mov_b32 v30, 157696
  v_mov_b32 v31, 1
  s_mov_b64 exec, 1
  ds_add_rtn_u32 v31, v30, v31
  s_waitcnt lgkmcnt(0)
  s_mov_b64 exec, -1
  s_nop 0
  v_readfirstlane_b32 s63, v31
  s_nop 3
  s_cmp_eq_u32 s63, 3
  s_cbranch_scc0 L_mx_pubh_np
  s_lshl_b32 s62, s18, 4
  s_add_u32 s62, s62, s19
  s_lshl_b32 s62, s62, 3
  s_add_u32 s62, s62, 12664832
  v_mov_b32 v29, s62
  s_xor_b32 s62, s76, s77
  v_mov_b32 v30, s75
  v_mov_b32 v31, s62
  s_mov_b64 exec, 1
  s_cmp_eq_u32 s78, 1
  s_cbranch_scc1 L_mx_pubh_fp
  buffer_store_dwordx2 v[30:31], v29, s[48:51], 0 offen sc1
  s_branch L_mx_pubh_fd
L_mx_pubh_fp:
  buffer_store_dwordx2 v[30:31], v29, s[48:51], 0 offen
L_mx_pubh_fd:
  s_mov_b64 exec, -1
L_mx_pubh_np:
  v_and_b32 v24, 31, v1
  v_lshlrev_b32 v24, 2, v24
  v_lshrrev_b32 v25, 5, v1
  v_lshlrev_b32 v25, 9, v25
  v_add_u32 v24, v24, v25
  s_lshl_b32 s30, s3, 13
  s_add_u32 s30, s30, 122880
  v_add_u32 v24, s30, v24
  s_nop 7
  v_cvt_pk_bf16_f32 v64, v168, v184
  v_cvt_pk_bf16_f32 v65, v169, v185
  v_cvt_pk_bf16_f32 v66, v170, v186
  v_cvt_pk_bf16_f32 v67, v171, v187
  v_cvt_pk_bf16_f32 v68, v172, v188
  v_cvt_pk_bf16_f32 v69, v173, v189
  v_cvt_pk_bf16_f32 v70, v174, v190
  v_cvt_pk_bf16_f32 v71, v175, v191
  v_cvt_pk_bf16_f32 v72, v176, v192
  v_cvt_pk_bf16_f32 v73, v177, v193
  v_cvt_pk_bf16_f32 v74, v178, v194
  v_cvt_pk_bf16_f32 v75, v179, v195
  v_cvt_pk_bf16_f32 v76, v180, v196
  v_cvt_pk_bf16_f32 v77, v181, v197
  v_cvt_pk_bf16_f32 v78, v182, v198
  v_cvt_pk_bf16_f32 v79, v183, v199
  v_cvt_pk_bf16_f32 v80, v200, v216
  v_cvt_pk_bf16_f32 v81, v201, v217
  v_cvt_pk_bf16_f32 v82, v202, v218
  v_cvt_pk_bf16_f32 v83, v203, v219
  v_cvt_pk_bf16_f32 v84, v204, v220
  v_cvt_pk_bf16_f32 v85, v205, v221
  v_cvt_pk_bf16_f32 v86, v206, v222
  v_cvt_pk_bf16_f32 v87, v207, v223
  v_cvt_pk_bf16_f32 v88, v208, v224
  v_cvt_pk_bf16_f32 v89, v209, v225
  v_cvt_pk_bf16_f32 v90, v210, v226
  v_cvt_pk_bf16_f32 v91, v211, v227
  v_cvt_pk_bf16_f32 v92, v212, v228
  v_cvt_pk_bf16_f32 v93, v213, v229
  v_cvt_pk_bf16_f32 v94, v214, v230
  v_cvt_pk_bf16_f32 v95, v215, v231
  ds_write_b32 v24, v64 offset:0
  ds_write_b32 v24, v65 offset:128
  ds_write_b32 v24, v66 offset:256
  ds_write_b32 v24, v67 offset:384
  ds_write_b32 v24, v68 offset:1024
  ds_write_b32 v24, v69 offset:1152
  ds_write_b32 v24, v70 offset:1280
  ds_write_b32 v24, v71 offset:1408
  ds_write_b32 v24, v72 offset:2048
  ds_write_b32 v24, v73 offset:2176
  ds_write_b32 v24, v74 offset:2304
  ds_write_b32 v24, v75 offset:2432
  ds_write_b32 v24, v76 offset:3072
  ds_write_b32 v24, v77 offset:3200
  ds_write_b32 v24, v78 offset:3328
  ds_write_b32 v24, v79 offset:3456
  ds_write_b32 v24, v80 offset:4096
  ds_write_b32 v24, v81 offset:4224
  ds_write_b32 v24, v82 offset:4352
  ds_write_b32 v24, v83 offset:4480
  ds_write_b32 v24, v84 offset:5120
  ds_write_b32 v24, v85 offset:5248
  ds_write_b32 v24, v86 offset:5376
  ds_write_b32 v24, v87 offset:5504
  ds_write_b32 v24, v88 offset:6144
  ds_write_b32 v24, v89 offset:6272
  ds_write_b32 v24, v90 offset:6400
  ds_write_b32 v24, v91 offset:6528
  ds_write_b32 v24, v92 offset:7168
  ds_write_b32 v24, v93 offset:7296
  ds_write_b32 v24, v94 offset:7424
  ds_write_b32 v24, v95 offset:7552
  s_waitcnt lgkmcnt(0)
  v_mov_b32 v30, 157700
  v_mov_b32 v31, 1
  s_mov_b64 exec, 1
  ds_add_rtn_u32 v31, v30, v31
  s_waitcnt lgkmcnt(0)
  s_mov_b64 exec, -1
  s_nop 0
  v_readfirstlane_b32 s63, v31
  s_nop 3
  v_mov_b32 v30, 157700
L_mx_rv:
  ds_read_b32 v31, v30
  s_waitcnt lgkmcnt(0)
  s_nop 0
  v_readfirstlane_b32 s63, v31
  s_nop 3
  s_cmp_ge_u32 s63, 4
  s_cbranch_scc1 L_mx_rv_ok
  s_sub_u32 s74, s74, 1
  s_cmp_eq_u32 s74, 0
  s_cbranch_scc0 L_mx_rv
L_mx_rv_ok:
  v_and_b32 v24, 31, v1
  v_lshlrev_b32 v24, 2, v24
  v_lshrrev_b32 v25, 5, v1
  v_lshlrev_b32 v26, 7, v25
  v_add_u32 v24, v24, v26
  s_lshl_b32 s30, s3, 10
  s_add_u32 s30, s30, 122880
  v_add_u32 v24, s30, v24
  ds_read_b32 v64, v24 offset:0
  ds_read_b32 v65, v24 offset:8192
  ds_read_b32 v66, v24 offset:16384
  ds_read_b32 v67, v24 offset:24576
  ds_read_b32 v68, v24 offset:256
  ds_read_b32 v69, v24 offset:8448
  ds_read_b32 v70, v24 offset:16640
  ds_read_b32 v71, v24 offset:24832
  ds_read_b32 v72, v24 offset:512
  ds_read_b32 v73, v24 offset:8704
  ds_read_b32 v74, v24 offset:16896
  ds_read_b32 v75, v24 offset:25088
  ds_read_b32 v76, v24 offset:768
  ds_read_b32 v77, v24 offset:8960
  ds_read_b32 v78, v24 offset:17152
  ds_read_b32 v79, v24 offset:25344
  ds_read_b32 v80, v24 offset:4096
  ds_read_b32 v81, v24 offset:12288
  ds_read_b32 v82, v24 offset:20480
  ds_read_b32 v83, v24 offset:28672
  ds_read_b32 v84, v24 offset:4352
  ds_read_b32 v85, v24 offset:12544
  ds_read_b32 v86, v24 offset:20736
  ds_read_b32 v87, v24 offset:28928
  ds_read_b32 v88, v24 offset:4608
  ds_read_b32 v89, v24 offset:12800
  ds_read_b32 v90, v24 offset:20992
  ds_read_b32 v91, v24 offset:29184
  ds_read_b32 v92, v24 offset:4864
  ds_read_b32 v93, v24 offset:13056
  ds_read_b32 v94, v24 offset:21248
  ds_read_b32 v95, v24 offset:29440
  v_and_b32 v26, 31, v1
  s_lshl_b32 s30, s19, 5
  v_add_u32 v27, s30, v26
  v_mov_b32 v28, 160
  v_cndmask_b32 v29, v27, v28, s[40:41]
  v_sub_u32 v27, 320, v27
  s_mov_b32 s30, 83968
  v_mul_lo_u32 v25, s30, v25
  v_lshlrev_b32 v29, 4, v29
  v_add_u32 v29, v29, v25
  v_lshlrev_b32 v27, 4, v27
  v_add_u32 v27, v27, v25
  s_mul_i32 s30, s3, 671744
  s_mul_i32 s31, s18, 5248
  s_add_u32 s30, s30, s31
  s_add_u32 s30, s30, 9814016
  s_waitcnt lgkmcnt(0)
  s_add_u32 s31, s30, 0
  buffer_store_dwordx4 v[64:67], v29, s[36:39], s31 offen sc1
  s_add_u32 s31, s30, 167936
  buffer_store_dwordx4 v[68:71], v29, s[36:39], s31 offen sc1
  s_add_u32 s31, s30, 335872
  buffer_store_dwordx4 v[72:75], v29, s[36:39], s31 offen sc1
  s_add_u32 s31, s30, 503808
  buffer_store_dwordx4 v[76:79], v29, s[36:39], s31 offen sc1
  s_add_u32 s31, s30, 0
  buffer_store_dwordx4 v[80:83], v27, s[36:39], s31 offen sc1
  s_add_u32 s31, s30, 167936
  buffer_store_dwordx4 v[84:87], v27, s[36:39], s31 offen sc1
  s_add_u32 s31, s30, 335872
  buffer_store_dwordx4 v[88:91], v27, s[36:39], s31 offen sc1
  s_add_u32 s31, s30, 503808
  buffer_store_dwordx4 v[92:95], v27, s[36:39], s31 offen sc1
  s_cmp_eq_u32 s19, 0
  s_cbranch_scc0 L_mx_noz
  s_cmp_eq_u32 s3, 0
  s_cbranch_scc0 L_mx_noz
  s_mov_b32 s30, 83968
  v_and_b32 v24, 31, v1
  v_mul_lo_u32 v24, s30, v24
  v_mov_b32 v4, 0
  v_mov_b32 v5, 0
  v_mov_b32 v6, 0
  v_mov_b32 v7, 0
  s_mul_i32 s31, s18, 5248
  s_add_u32 s31, s31, 9814016
  buffer_store_dwordx4 v[4:7], v24, s[36:39], s31 offen sc1
L_mx_noz:
  s_waitcnt vmcnt(0)
  v_mov_b32 v30, 157704
  v_mov_b32 v31, 1
  s_mov_b64 exec, 1
  ds_add_rtn_u32 v31, v30, v31
  s_waitcnt lgkmcnt(0)
  s_mov_b64 exec, -1
  s_nop 0
  v_readfirstlane_b32 s63, v31
  s_nop 3
  s_cmp_eq_u32 s63, 3
  s_cbranch_scc0 L_mx_pubt_np
  s_lshl_b32 s62, s19, 4
  s_add_u32 s62, s62, s18
  s_lshl_b32 s62, s62, 3
  s_add_u32 s62, s62, 12666880
  v_lshlrev_b32 v29, 10, v1
  v_add_u32 v29, s62, v29
  v_mov_b32 v30, s75
  v_mov_b32 v31, s76
  s_mov_b64 exec, 255
  buffer_store_dwordx2 v[30:31], v29, s[48:51], 0 offen sc1
  s_mov_b64 exec, -1
L_mx_pubt_np:
  s_endpgm
L_mx_flag1:
  s_lshl_b32 s62, s18, 4
  s_add_u32 s62, s62, s19
  s_lshl_b32 s62, s62, 3
  s_add_u32 s58, s62, 12652544
  s_lshl_b32 s62, s19, 4
  s_add_u32 s62, s62, s18
  s_lshl_b32 s62, s62, 3
  s_add_u32 s62, s62, 12654592
  s_cmp_eq_u32 s3, 1
  s_cselect_b32 s58, s62, s58
  v_mov_b32 v28, s58
  s_waitcnt vmcnt(0)
  s_xor_b32 s62, s76, s77
  v_mov_b32 v30, s75
  v_mov_b32 v31, s62
  s_mov_b64 exec, 1
  buffer_store_dwordx2 v[30:31], v28, s[48:51], 0 offen sc1
  s_mov_b64 exec, -1
  s_branch L_mx_flag1_ret
L_loader:
  s_sub_u32 s21, s3, 4
  v_mov_b32 v11, 0
  v_mov_b32 v12, 0
  v_mov_b32 v13, 0
  v_mov_b32 v52, 0
  v_mov_b32 v53, 0
  v_mov_b32 v54, 0
  v_mov_b32 v55, 0
  v_mov_b32 v56, 0
  v_mov_b32 v57, 0
  v_mov_b32 v58, 0
  v_mov_b32 v59, 0
  s_mov_b32 s58, 0
  s_mov_b32 s59, 99
  s_mov_b32 s63, 0
  v_lshrrev_b32 v4, 3, v1
  s_mov_b32 s40, 81920
  v_mul_lo_u32 v8, s40, v4
  v_and_b32 v5, 7, v1
  v_lshrrev_b32 v6, 4, v1
  v_xor_b32 v5, v5, v6
  v_lshlrev_b32 v5, 4, v5
  v_add_u32 v2, v8, v5
  v_xor_b32 v7, 64, v5
  v_add_u32 v3, v8, v7
  v_add_u32 v3, 655360, v3
  s_lshl_b32 s40, s18, 1
  s_and_b32 s41, s21, 1
  s_add_u32 s40, s40, s41
  s_lshr_b32 s41, s21, 1
  s_lshl_b32 s41, s41, 5
  s_add_u32 s40, s40, s41
  s_mul_i32 s40, s40, 1280
  s_add_u32 s41, s40, 1310720
  s_mov_b64 s[56:57], -1
  s_cmp_lt_u32 s19, 5
  s_cbranch_scc0 L_ld_H
  s_cmp_ge_u32 s21, 2
  s_cbranch_scc0 L_ld_H
  s_and_b32 s50, s21, 1
  s_add_u32 s50, s50, 1
  s_mov_b32 s30, 819200
  v_mul_u32_u24 v8, 1280, v4
  v_add_u32 v9, v8, v5
  v_add_u32 v10, v8, v7
  v_add_u32 v10, 10240, v10
  s_mul_i32 s42, s19, 40960
  s_mov_b32 s44, s42
  s_mov_b32 s45, s42
  s_add_u32 s46, s42, 20480
  s_add_u32 s47, s42, 20480
  s_mov_b32 s43, 128
  s_cmp_eq_u32 s19, 0
  s_cbranch_scc0 L_ld_go
  s_cmp_eq_u32 s21, 3
  s_cbranch_scc0 L_ld_go
  s_mov_b32 s56, 0xffffff00
  s_branch L_ld_go
L_ld_H:
  s_mov_b32 s50, 0
  s_mov_b32 s30, 2211840
  v_mul_u32_u24 v8, 3456, v4
  v_and_b32 v9, 7, v1
  v_bfe_u32 v10, v1, 4, 1
  v_lshlrev_b32 v10, 2, v10
  v_xor_b32 v9, v9, v10
  v_lshlrev_b32 v9, 4, v9
  v_add_u32 v9, v8, v9
  v_mov_b32 v10, v9
  s_and_b32 s42, s21, 1
  s_mul_i32 s42, s42, 110592
  s_lshr_b32 s43, s21, 1
  s_lshl_b32 s43, s43, 6
  s_add_u32 s43, s43, s20
  s_lshl_b32 s43, s43, 1
  s_add_u32 s42, s42, s43
  s_add_u32 s44, s42, 0
  s_add_u32 s45, s42, 27648
  s_add_u32 s46, s42, 55296
  s_add_u32 s47, s42, 82944
  s_mov_b32 s43, 221184
L_ld_go:
  s_lshl_b32 s48, s21, 12
  s_mov_b32 s31, 0x20000
  s_waitcnt lgkmcnt(0)
  s_mov_b32 s62, 12648448
  s_load_dword s75, s[16:17], s62
  s_mov_b32 s24, s4
  s_mov_b32 s25, s5
  s_mov_b32 s26, 2621440
  s_mov_b32 s27, 0x20000
  s_cmp_eq_u32 s50, 1
  s_cselect_b32 s28, s10, s64
  s_cselect_b32 s29, s11, s65
  s_cmp_eq_u32 s50, 2
  s_cselect_b32 s28, s12, s28
  s_cselect_b32 s29, s13, s29
  s_mov_b32 s49, s48
  s_add_u32 m0, s49, 0
  s_nop 0
  buffer_load_dwordx4 v2, s[24:27], s40 offen lds
  s_add_u32 m0, s49, 16384
  s_mov_b64 exec, s[56:57]
  buffer_load_dwordx4 v9, s[28:31], s44 offen lds
  s_mov_b64 exec, -1
  s_add_u32 m0, s49, 1024
  s_nop 0
  buffer_load_dwordx4 v3, s[24:27], s40 offen lds
  s_add_u32 m0, s49, 17408
  s_nop 0
  buffer_load_dwordx4 v10, s[28:31], s45 offen lds
  s_add_u32 m0, s49, 2048
  s_nop 0
  buffer_load_dwordx4 v2, s[24:27], s41 offen lds
  s_add_u32 m0, s49, 18432
  s_nop 0
  buffer_load_dwordx4 v9, s[28:31], s46 offen lds
  s_add_u32 m0, s49, 3072
  s_nop 0
  buffer_load_dwordx4 v3, s[24:27], s41 offen lds
  s_add_u32 m0, s49, 19456
  s_nop 0
  buffer_load_dwordx4 v10, s[28:31], s47 offen lds
  s_add_u32 s40, s40, 128
  s_add_u32 s41, s41, 128
  s_add_u32 s44, s44, s43
  s_add_u32 s45, s45, s43
  s_add_u32 s46, s46, s43
  s_add_u32 s47, s47, s43
  s_add_u32 s49, s49, 32768
  s_cmp_ge_u32 s49, 131072
  s_cselect_b32 s52, 131072, 0
  s_sub_u32 s49, s49, s52
  s_add_u32 m0, s49, 0
  s_nop 0
  buffer_load_dwordx4 v2, s[24:27], s40 offen lds
  s_add_u32 m0, s49, 16384
  s_mov_b64 exec, s[56:57]
  buffer_load_dwordx4 v9, s[28:31], s44 offen lds
  s_mov_b64 exec, -1
  s_add_u32 m0, s49, 1024
  s_nop 0
  buffer_load_dwordx4 v3, s[24:27], s40 offen lds
  s_add_u32 m0, s49, 17408
  s_nop 0
  buffer_load_dwordx4 v10, s[28:31], s45 offen lds
  s_add_u32 m0, s49, 2048
  s_nop 0
  buffer_load_dwordx4 v2, s[24:27], s41 offen lds
  s_add_u32 m0, s49, 18432
  s_nop 0
  buffer_load_dwordx4 v9, s[28:31], s46 offen lds
  s_add_u32 m0, s49, 3072
  s_nop 0
  buffer_load_dwordx4 v3, s[24:27], s41 offen lds
  s_add_u32 m0, s49, 19456
  s_nop 0
  buffer_load_dwordx4 v10, s[28:31], s47 offen lds
  s_add_u32 s40, s40, 128
  s_add_u32 s41, s41, 128
  s_add_u32 s44, s44, s43
  s_add_u32 s45, s45, s43
  s_add_u32 s46, s46, s43
  s_add_u32 s47, s47, s43
  s_add_u32 s49, s49, 32768
  s_cmp_ge_u32 s49, 131072
  s_cselect_b32 s52, 131072, 0
  s_sub_u32 s49, s49, s52
  s_mov_b32 s36, s16
  s_mov_b32 s37, s17
  s_mov_b32 s38, 12675072
  s_mov_b32 s39, 0x20000
  s_mov_b32 s32, s16
  s_mov_b32 s33, s17
  s_mov_b32 s34, 12675072
  s_mov_b32 s35, 0x20000
  s_waitcnt lgkmcnt(0)
  s_add_u32 s75, s75, 1
  s_xor_b32 s76, s75, 1513920225
  s_cmp_ge_u32 s21, 2
  s_cbranch_scc0 L_ld_su01
  s_sub_u32 s58, s21, 2
  s_lshl_b32 s59, s72, 1
  s_add_u32 s59, s59, s58
  s_mov_b32 s50, 6554
  s_mov_b32 s53, 1280
  v_add_u32 v22, 0, v1
  v_mul_lo_u32 v23, s50, v22
  v_lshrrev_b32 v23, 16, v23
  v_mul_u32_u24 v24, 10, v23
  v_sub_u32 v24, v22, v24
  v_lshlrev_b32 v24, 4, v24
  v_mul_lo_u32 v23, s53, v23
  v_add_u32 v52, v23, v24
  v_add_u32 v22, 64, v1
  v_mul_lo_u32 v23, s50, v22
  v_lshrrev_b32 v23, 16, v23
  v_mul_u32_u24 v24, 10, v23
  v_sub_u32 v24, v22, v24
  v_lshlrev_b32 v24, 4, v24
  v_mul_lo_u32 v23, s53, v23
  v_add_u32 v53, v23, v24
  v_add_u32 v22, 128, v1
  v_mul_lo_u32 v23, s50, v22
  v_lshrrev_b32 v23, 16, v23
  v_mul_u32_u24 v24, 10, v23
  v_sub_u32 v24, v22, v24
  v_lshlrev_b32 v24, 4, v24
  v_mul_lo_u32 v23, s53, v23
  v_add_u32 v54, v23, v24
  v_add_u32 v22, 192, v1
  v_mul_lo_u32 v23, s50, v22
  v_lshrrev_b32 v23, 16, v23
  v_mul_u32_u24 v24, 10, v23
  v_sub_u32 v24, v22, v24
  v_lshlrev_b32 v24, 4, v24
  v_mul_lo_u32 v23, s53, v23
  v_add_u32 v55, v23, v24
  v_add_u32 v22, 256, v1
  v_mul_lo_u32 v23, s50, v22
  v_lshrrev_b32 v23, 16, v23
  v_mul_u32_u24 v24, 10, v23
  v_sub_u32 v24, v22, v24
  v_lshlrev_b32 v24, 4, v24
  v_mul_lo_u32 v23, s53, v23
  v_add_u32 v56, v23, v24
  v_lshrrev_b32 v23, 4, v1
  v_lshrrev_b32 v24, 1, v23
  v_lshlrev_b32 v24, 4, v24
  v_and_b32 v25, 1, v23
  v_lshlrev_b32 v25, 2, v25
  v_add_u32 v24, v24, v25
  v_bfe_u32 v25, v1, 2, 2
  v_add_u32 v24, v24, v25
  v_mul_u32_u24 v24, 160, v24
  v_and_b32 v25, 3, v1
  v_lshlrev_b32 v25, 3, v25
  v_add_u32 v24, v24, v25
  s_mul_i32 s50, s58, 5120
  s_add_u32 s50, s50, 135168
  v_add_u32 v57, s50, v24
  s_lshl_b32 s50, s73, 6
  s_add_u32 s50, s50, s59
  s_lshl_b32 s50, s50, 3
  s_add_u32 s50, s50, 12656640
  v_mov_b32 v58, s50
  s_branch L_ld_sud
L_ld_su01:
  v_lshlrev_b32 v13, 3, v1
  v_and_b32 v16, 31, v1
  v_lshlrev_b32 v15, 3, v16
  s_lshl_b32 s50, s18, 7
  s_add_u32 s50, s50, 12652544
  v_add_u32 v12, s50, v15
  s_lshl_b32 s50, s19, 7
  s_add_u32 s50, s50, 12654464
  v_add_u32 v15, s50, v15
  v_cmp_le_u32 vcc, 16, v16
  s_nop 1
  v_cndmask_b32 v12, v12, v15, vcc
  s_lshl_b32 s50, s73, 9
  s_add_u32 s50, s50, 12656640
  v_add_u32 v11, s50, v13
L_ld_sud:
  s_waitcnt vmcnt(8)
  s_barrier
  s_add_u32 m0, s49, 0
  s_nop 0
  buffer_load_dwordx4 v2, s[24:27], s40 offen lds
  s_add_u32 m0, s49, 16384
  s_mov_b64 exec, s[56:57]
  buffer_load_dwordx4 v9, s[28:31], s44 offen lds
  s_mov_b64 exec, -1
  s_add_u32 m0, s49, 1024
  s_nop 0
  buffer_load_dwordx4 v3, s[24:27], s40 offen lds
  s_add_u32 m0, s49, 17408
  s_nop 0
  buffer_load_dwordx4 v10, s[28:31], s45 offen lds
  s_add_u32 m0, s49, 2048
  s_nop 0
  buffer_load_dwordx4 v2, s[24:27], s41 offen lds
  s_add_u32 m0, s49, 18432
  s_nop 0
  buffer_load_dwordx4 v9, s[28:31], s46 offen lds
  s_add_u32 m0, s49, 3072
  s_nop 0
  buffer_load_dwordx4 v3, s[24:27], s41 offen lds
  s_add_u32 m0, s49, 19456
  s_nop 0
  buffer_load_dwordx4 v10, s[28:31], s47 offen lds
  s_add_u32 s40, s40, 128
  s_add_u32 s41, s41, 128
  s_add_u32 s44, s44, s43
  s_add_u32 s45, s45, s43
  s_add_u32 s46, s46, s43
  s_add_u32 s47, s47, s43
  s_add_u32 s49, s49, 32768
  s_cmp_ge_u32 s49, 131072
  s_cselect_b32 s52, 131072, 0
  s_sub_u32 s49, s49, s52
  s_cmp_ge_u32 s21, 2
  s_cbranch_scc1 L_ld_h1w
L_ld_h1w_ret:
  s_cmp_ge_u32 s21, 2
  s_cbranch_scc1 L_ld_b1w
  s_waitcnt vmcnt(8)
  s_branch L_ld_b1d
L_ld_b1w:
  s_cmp_ge_u32 s59, 54
  s_cbranch_scc1 L_ld_b1n
  s_waitcnt vmcnt(13)
  s_branch L_ld_b1d
L_ld_b1n:
  s_waitcnt vmcnt(8)
L_ld_b1d:
  s_barrier
  s_mov_b32 s53, 99
  s_mov_b32 s54, 99
  s_mov_b32 s55, 0
  s_mov_b32 s79, 99
  s_mov_b32 s81, 99
  s_mov_b32 s82, 99
  s_mov_b32 s83, 0
  s_cmp_eq_u32 s21, 0
  s_cselect_b32 s53, 4, s53
  s_cselect_b32 s54, 2, s54
  s_cselect_b32 s55, 3, s55
  s_cselect_b32 s81, 2, s81
  s_cmp_eq_u32 s21, 1
  s_cselect_b32 s53, 1, s53
  s_cmp_ge_u32 s21, 2
  s_cselect_b32 s82, 6, s82
  s_cselect_b32 s79, 3, s79
  s_cselect_b32 s83, 1, s83
  s_mov_b32 s51, 7
L_ld_loop:
  s_cmp_eq_u32 s51, s54
  s_cbranch_scc1 L_ld_h2
L_ld_h2_ret:
  s_add_u32 m0, s49, 0
  s_nop 0
  buffer_load_dwordx4 v2, s[24:27], s40 offen lds
  s_add_u32 m0, s49, 16384
  s_mov_b64 exec, s[56:57]
  buffer_load_dwordx4 v9, s[28:31], s44 offen lds
  s_mov_b64 exec, -1
  s_add_u32 m0, s49, 1024
  s_nop 0
  buffer_load_dwordx4 v3, s[24:27], s40 offen lds
  s_add_u32 m0, s49, 17408
  s_nop 0
  buffer_load_dwordx4 v10, s[28:31], s45 offen lds
  s_add_u32 m0, s49, 2048
  s_nop 0
  buffer_load_dwordx4 v2, s[24:27], s41 offen lds
  s_add_u32 m0, s49, 18432
  s_nop 0
  buffer_load_dwordx4 v9, s[28:31], s46 offen lds
  s_add_u32 m0, s49, 3072
  s_nop 0
  buffer_load_dwordx4 v3, s[24:27], s41 offen lds
  s_add_u32 m0, s49, 19456
  s_nop 0
  buffer_load_dwordx4 v10, s[28:31], s47 offen lds
  s_add_u32 s40, s40, 128
  s_add_u32 s41, s41, 128
  s_add_u32 s44, s44, s43
  s_add_u32 s45, s45, s43
  s_add_u32 s46, s46, s43
  s_add_u32 s47, s47, s43
  s_add_u32 s49, s49, 32768
  s_cmp_ge_u32 s49, 131072
  s_cselect_b32 s52, 131072, 0
  s_sub_u32 s49, s49, s52
  s_cmp_eq_u32 s51, s79
  s_cbranch_scc1 L_ld_h3
L_ld_h3_ret:
  s_cmp_eq_u32 s51, s53
  s_cbranch_scc1 L_ld_h1
L_ld_h1_ret:
  s_cmp_eq_u32 s51, s81
  s_cbranch_scc1 L_ld_h4
L_ld_h4_ret:
  s_cmp_eq_u32 s51, s82
  s_cbranch_scc1 L_ld_h2w
L_ld_h2w_ret:
  s_cmp_lt_u32 s51, s55
  s_cbranch_scc1 L_ld_w25
  s_cmp_eq_u32 s83, 0
  s_cbranch_scc1 L_ld_w8
  s_cmp_eq_u32 s51, 6
  s_cbranch_scc1 L_ld_wW
  s_cmp_eq_u32 s51, 5
  s_cbranch_scc1 L_ld_wW
  s_cmp_eq_u32 s51, 3
  s_cbranch_scc1 L_ld_w9
  s_cmp_eq_u32 s51, 2
  s_cbranch_scc1 L_ld_w9
L_ld_w8:
  s_waitcnt vmcnt(8)
  s_branch L_ld_wd
L_ld_wW:
  s_cmp_ge_u32 s59, 54
  s_cbranch_scc1 L_ld_w8
  s_waitcnt vmcnt(13)
  s_branch L_ld_wd
L_ld_w9:
  s_waitcnt vmcnt(9)
  s_branch L_ld_wd
L_ld_w25:
  s_waitcnt vmcnt(17)
L_ld_wd:
  s_barrier
  s_sub_u32 s51, s51, 1
  s_cmp_lg_u32 s51, 0
  s_cbranch_scc1 L_ld_loop
  s_waitcnt vmcnt(0)
  s_cmp_eq_u32 s21, 0
  s_cbranch_scc0 L_ld_nored
  s_setprio 2
  v_add_f32 v16, v16, v20
  v_add_f32 v17, v17, v21
  v_add_f32 v18, v18, v22
  v_add_f32 v19, v19, v23
  v_add_f32 v16, v16, v24
  v_add_f32 v17, v17, v25
  v_add_f32 v18, v18, v26
  v_add_f32 v19, v19, v27
  v_add_f32 v16, v16, v28
  v_add_f32 v17, v17, v29
  v_add_f32 v18, v18, v30
  v_add_f32 v19, v19, v31
  v_add_f32 v16, v16, v32
  v_add_f32 v17, v17, v33
  v_add_f32 v18, v18, v34
  v_add_f32 v19, v19, v35
  v_add_f32 v16, v16, v36
  v_add_f32 v17, v17, v37
  v_add_f32 v18, v18, v38
  v_add_f32 v19, v19, v39
  v_add_f32 v16, v16, v40
  v_add_f32 v17, v17, v41
  v_add_f32 v18, v18, v42
  v_add_f32 v19, v19, v43
  v_add_f32 v16, v16, v44
  v_add_f32 v17, v17, v45
  v_add_f32 v18, v18, v46
  v_add_f32 v19, v19, v47
  v_mov_b32 v20, v16
  v_mov_b32 v21, v17
  v_mov_b32 v22, v18
  v_mov_b32 v23, v19
  s_nop 1
  v_permlane32_swap_b32 v16, v20
  v_permlane32_swap_b32 v17, v21
  v_permlane32_swap_b32 v18, v22
  v_permlane32_swap_b32 v19, v23
  s_nop 0
  v_add_f32 v16, v16, v20
  v_add_f32 v17, v17, v21
  v_add_f32 v18, v18, v22
  v_add_f32 v19, v19, v23
  v_add_u32 v13, 156672, v13
  ds_write_b128 v13, v[16:19]
  s_setprio 0
  s_waitcnt lgkmcnt(0)
L_ld_nored:
  s_barrier
  s_barrier
  s_branch L_ld_p2
L_ld_h1:
  s_cmp_eq_u32 s21, 1
  s_cbranch_scc1 L_ld_h1f
  buffer_load_dwordx2 v[14:15], v12, s[32:35], 0 offen sc1
  s_branch L_ld_h1_ret
L_ld_h1f:
  buffer_load_dwordx2 v[48:49], v11, s[32:35], 0 offen sc1
  s_branch L_ld_h1_ret
L_ld_h1w:
  s_cmp_ge_u32 s59, 54
  s_cbranch_scc1 L_ld_h1w_ret
  s_mov_b32 s84, s66
  s_mov_b32 s85, s67
  s_mov_b32 s86, 2211840
  s_mov_b32 s87, 0x20000
  s_mul_i32 s50, s59, 40960
  s_mul_i32 s62, s73, 160
  s_add_u32 s50, s50, s62
  s_mul_i32 s62, s58, 5120
  s_add_u32 s62, s62, 135168
  s_add_u32 m0, s62, 0
  s_nop 0
  buffer_load_dwordx4 v52, s[84:87], s50 offen lds
  s_add_u32 m0, s62, 1024
  s_nop 0
  buffer_load_dwordx4 v53, s[84:87], s50 offen lds
  s_add_u32 m0, s62, 2048
  s_nop 0
  buffer_load_dwordx4 v54, s[84:87], s50 offen lds
  s_add_u32 m0, s62, 3072
  s_nop 0
  buffer_load_dwordx4 v55, s[84:87], s50 offen lds
  s_add_u32 m0, s62, 4096
  s_nop 0
  buffer_load_dwordx4 v56, s[84:87], s50 offen lds
  s_branch L_ld_h1w_ret
L_ld_h2:
L_ld_sp:
  v_xor_b32 v15, s76, v15
  v_cmp_ne_u32 vcc, s75, v14
  v_cmp_lt_u32 s[60:61], 15, v15
  s_nop 3
  s_or_b64 vcc, vcc, s[60:61]
  s_cbranch_vccz L_ld_sp_ok
  s_sub_u32 s74, s74, 1
  s_cmp_eq_u32 s74, 0
  s_cbranch_scc1 L_ld_sp_ok
  s_sleep 4
  buffer_load_dwordx2 v[14:15], v12, s[32:35], 0 offen sc1
  s_waitcnt vmcnt(0)
  s_branch L_ld_sp
L_ld_sp_ok:
  v_and_b32 v50, 16, v1
  v_cmp_eq_u32 s[60:61], 0, v50
  v_cmp_ne_u32 vcc, s77, v15
  s_nop 3
  s_and_b64 vcc, vcc, s[60:61]
  s_cmp_eq_u64 vcc, 0
  s_cselect_b32 s62, 1, 0
  v_mov_b32 v50, 157708
  v_mov_b32 v51, s62
  ds_write_b32 v50, v51
  s_branch L_ld_h2_ret
L_ld_h4:
  s_lshl_b32 s50, s18, 10
  s_add_u32 s50, s50, 12500992
  s_mov_b32 m0, 155648
  v_lshlrev_b32 v13, 4, v1
  buffer_load_dwordx4 v13, s[36:39], s50 offen sc1 lds
  s_lshl_b32 s50, s20, 2
  s_add_u32 s50, s50, 12517376
  v_and_b32 v13, 31, v1
  v_lshlrev_b32 v13, 4, v13
  v_lshrrev_b32 v14, 5, v1
  v_lshlrev_b32 v14, 13, v14
  v_add_u32 v14, v13, v14
  buffer_load_dwordx4 v[16:19], v14, s[36:39], s50 offen sc1
  s_add_u32 s50, s50, 16384
  buffer_load_dwordx4 v[20:23], v14, s[36:39], s50 offen sc1
  s_add_u32 s50, s50, 16384
  buffer_load_dwordx4 v[24:27], v14, s[36:39], s50 offen sc1
  s_add_u32 s50, s50, 16384
  buffer_load_dwordx4 v[28:31], v14, s[36:39], s50 offen sc1
  s_add_u32 s50, s50, 16384
  buffer_load_dwordx4 v[32:35], v14, s[36:39], s50 offen sc1
  s_add_u32 s50, s50, 16384
  buffer_load_dwordx4 v[36:39], v14, s[36:39], s50 offen sc1
  s_add_u32 s50, s50, 16384
  buffer_load_dwordx4 v[40:43], v14, s[36:39], s50 offen sc1
  s_add_u32 s50, s50, 16384
  buffer_load_dwordx4 v[44:47], v14, s[36:39], s50 offen sc1
  s_branch L_ld_h4_ret
L_ld_h2w:
  v_lshlrev_b32 v22, 4, v1
  s_cmp_ge_u32 s59, 54
  s_cbranch_scc1 L_ld_h2w_ret
  ds_read_b64_tr_b16 v[24:25], v57 offset:0
  ds_read_b64_tr_b16 v[26:27], v57 offset:1280
  ds_read_b64_tr_b16 v[28:29], v57 offset:32
  ds_read_b64_tr_b16 v[30:31], v57 offset:1312
  ds_read_b64_tr_b16 v[32:33], v57 offset:64
  ds_read_b64_tr_b16 v[34:35], v57 offset:1344
  ds_read_b64_tr_b16 v[36:37], v57 offset:96
  ds_read_b64_tr_b16 v[38:39], v57 offset:1376
  ds_read_b64_tr_b16 v[40:41], v57 offset:128
  ds_read_b64_tr_b16 v[42:43], v57 offset:1408
  s_mul_i32 s50, s73, 54
  s_add_u32 s50, s50, s59
  s_mul_i32 s50, s50, 5120
  s_add_u32 s50, s50, 7602176
  v_add_u32 v23, 4096, v22
  s_waitcnt lgkmcnt(0)
  buffer_store_dwordx4 v[24:27], v22, s[32:35], s50 offen offset:0 sc1
  buffer_store_dwordx4 v[28:31], v22, s[32:35], s50 offen offset:1024 sc1
  buffer_store_dwordx4 v[32:35], v22, s[32:35], s50 offen offset:2048 sc1
  buffer_store_dwordx4 v[36:39], v22, s[32:35], s50 offen offset:3072 sc1
  buffer_store_dwordx4 v[40:43], v23, s[32:35], s50 offen sc1
  s_branch L_ld_h2w_ret
L_ld_h3:
  s_xor_b32 s62, s76, s77
  v_mov_b32 v64, s75
  v_mov_b32 v65, s62
  s_mov_b64 exec, 1
  buffer_store_dwordx2 v[64:65], v58, s[32:35], 0 offen sc1
  s_mov_b64 exec, -1
  s_branch L_ld_h3_ret
L_ld_p2:
  v_mov_b32 v16, 157716
  s_cmp_eq_u32 s21, 1
  s_cbranch_scc0 L_ld_ww
L_ld_spw:
  v_xor_b32 v49, s76, v49
  v_cmp_ne_u32 vcc, s75, v48
  v_cmp_lt_u32 s[60:61], 15, v49
  s_nop 3
  s_or_b64 vcc, vcc, s[60:61]
  s_cbranch_vccz L_ld_spw_ok
  s_sub_u32 s74, s74, 1
  s_cmp_eq_u32 s74, 0
  s_cbranch_scc1 L_ld_spw_ok
  s_sleep 4
  buffer_load_dwordx2 v[48:49], v11, s[32:35], 0 offen sc1
  s_waitcnt vmcnt(0)
  s_branch L_ld_spw
L_ld_spw_ok:
  v_mov_b32 v17, 1
  ds_write_b32 v16, v17
  s_waitcnt lgkmcnt(0)
  s_branch L_ld_wgo
L_ld_ww:
  ds_read_b32 v17, v16
  s_waitcnt lgkmcnt(0)
  s_nop 0
  v_readfirstlane_b32 s50, v17
  s_nop 3
  s_cmp_eq_u32 s50, 1
  s_cbranch_scc1 L_ld_wgo
  s_sub_u32 s74, s74, 1
  s_cmp_eq_u32 s74, 0
  s_cbranch_scc0 L_ld_ww
L_ld_wgo:
  s_mov_b32 s24, s16
  s_mov_b32 s25, s17
  s_mov_b32 s26, 12675072
  s_mov_b32 s27, 0x20000
  v_lshlrev_b32 v2, 4, v1
  v_add_u32 v3, 4096, v2
  s_add_u32 s44, s21, 12
  s_mov_b32 s45, s44
  s_mul_i32 s49, s73, 276480
  s_add_u32 s49, s49, 7602176
  s_mul_i32 s50, s44, 5120
  s_add_u32 s50, s50, s49
  buffer_load_dwordx4 v[96:99], v2, s[24:27], s50 offen offset:0 sc1
  buffer_load_dwordx4 v[100:103], v2, s[24:27], s50 offen offset:1024 sc1
  buffer_load_dwordx4 v[104:107], v2, s[24:27], s50 offen offset:2048 sc1
  buffer_load_dwordx4 v[108:111], v2, s[24:27], s50 offen offset:3072 sc1
  buffer_load_dwordx4 v[112:115], v3, s[24:27], s50 offen sc1
  s_add_u32 s44, s44, 4
  s_cmp_ge_u32 s44, 54
  s_cselect_b32 s44, s21, s44
  s_mul_i32 s50, s44, 5120
  s_add_u32 s50, s50, s49
  buffer_load_dwordx4 v[132:135], v2, s[24:27], s50 offen offset:0 sc1
  buffer_load_dwordx4 v[136:139], v2, s[24:27], s50 offen offset:1024 sc1
  buffer_load_dwordx4 v[140:143], v2, s[24:27], s50 offen offset:2048 sc1
  buffer_load_dwordx4 v[144:147], v2, s[24:27], s50 offen offset:3072 sc1
  buffer_load_dwordx4 v[148:151], v3, s[24:27], s50 offen sc1
  s_add_u32 s44, s44, 4
  s_cmp_ge_u32 s44, 54
  s_cselect_b32 s44, s21, s44
  s_mul_i32 s50, s44, 5120
  s_add_u32 s50, s50, s49
  buffer_load_dwordx4 v[168:171], v2, s[24:27], s50 offen offset:0 sc1
  buffer_load_dwordx4 v[172:175], v2, s[24:27], s50 offen offset:1024 sc1
  buffer_load_dwordx4 v[176:179], v2, s[24:27], s50 offen offset:2048 sc1
  buffer_load_dwordx4 v[180:183], v2, s[24:27], s50 offen offset:3072 sc1
  buffer_load_dwordx4 v[184:187], v3, s[24:27], s50 offen sc1
  s_add_u32 s44, s44, 4
  s_cmp_ge_u32 s44, 54
  s_cselect_b32 s44, s21, s44
  s_lshr_b32 s50, s72, 1
  s_lshl_b32 s50, s50, 7
  s_add_u32 s50, s50, 12664832
  v_min_u32 v14, 10, v1
  v_add_u32 v14, 5, v14
  v_lshlrev_b32 v14, 3, v14
  v_add_u32 v15, s50, v14
  s_cmp_eq_u32 s21, 0
  s_cbranch_scc0 L_p2_np0
  buffer_load_dwordx2 v[214:215], v15, s[24:27], 0 offen sc1
L_p2_np0:
  s_mov_b32 s28, s16
  s_mov_b32 s29, s17
  s_mov_b32 s30, 237568
  s_mov_b32 s31, 0x20000
  s_mul_i32 s50, s72, 237568
  s_add_u32 s28, s28, s50
  s_addc_u32 s29, s29, 0
  s_mov_b32 s32, s4
  s_mov_b32 s33, s5
  s_mov_b32 s34, 2621440
  s_mov_b32 s35, 0x20000
  s_mov_b32 s40, s68
  s_mov_b32 s41, s69
  s_mov_b32 s42, 2621440
  s_mov_b32 s43, 0x20000
  s_add_u32 s50, s21, 0
  s_and_b32 s50, s50, 3
  s_mul_i32 s50, s50, 59392
  v_add_u32 v4, s50, v2
  s_add_u32 s50, s21, 1
  s_and_b32 s50, s50, 3
  s_mul_i32 s50, s50, 59392
  v_add_u32 v5, s50, v2
  s_add_u32 s50, s21, 2
  s_and_b32 s50, s50, 3
  s_mul_i32 s50, s50, 59392
  v_add_u32 v6, s50, v2
  s_add_u32 s50, s21, 3
  s_and_b32 s50, s50, 3
  s_mul_i32 s50, s50, 59392
  v_add_u32 v7, s50, v2
  s_lshl_b32 s50, s21, 6
  v_add_u32 v8, s50, v1
  s_mov_b32 s50, 3277
  s_mul_i32 s38, s72, 1280
  s_mul_i32 s39, s73, 160
  s_add_u32 s38, s38, s39
  v_add_u32 v9, 0, v8
  v_mul_lo_u32 v10, s50, v9
  v_lshrrev_b32 v10, 16, v10
  v_mul_u32_u24 v11, 20, v10
  v_sub_u32 v11, v9, v11
  v_mul_u32_u24 v12, 336, v10
  v_lshlrev_b32 v13, 4, v11
  v_add_u32 v220, v12, v13
  v_lshrrev_b32 v12, 5, v10
  v_mul_u32_u24 v12, 40960, v12
  v_and_b32 v10, 31, v10
  v_mul_u32_u24 v10, 81920, v10
  v_lshlrev_b32 v11, 3, v11
  v_add3_u32 v225, v10, v12, v11
  v_add_u32 v9, 256, v8
  v_mul_lo_u32 v10, s50, v9
  v_lshrrev_b32 v10, 16, v10
  v_mul_u32_u24 v11, 20, v10
  v_sub_u32 v11, v9, v11
  v_mul_u32_u24 v12, 336, v10
  v_lshlrev_b32 v13, 4, v11
  v_add_u32 v221, v12, v13
  v_lshrrev_b32 v12, 5, v10
  v_mul_u32_u24 v12, 40960, v12
  v_and_b32 v10, 31, v10
  v_mul_u32_u24 v10, 81920, v10
  v_lshlrev_b32 v11, 3, v11
  v_add3_u32 v226, v10, v12, v11
  v_add_u32 v9, 512, v8
  v_mul_lo_u32 v10, s50, v9
  v_lshrrev_b32 v10, 16, v10
  v_mul_u32_u24 v11, 20, v10
  v_sub_u32 v11, v9, v11
  v_mul_u32_u24 v12, 336, v10
  v_lshlrev_b32 v13, 4, v11
  v_add_u32 v222, v12, v13
  v_lshrrev_b32 v12, 5, v10
  v_mul_u32_u24 v12, 40960, v12
  v_and_b32 v10, 31, v10
  v_mul_u32_u24 v10, 81920, v10
  v_lshlrev_b32 v11, 3, v11
  v_add3_u32 v227, v10, v12, v11
  v_add_u32 v9, 768, v8
  v_mul_lo_u32 v10, s50, v9
  v_lshrrev_b32 v10, 16, v10
  v_mul_u32_u24 v11, 20, v10
  v_sub_u32 v11, v9, v11
  v_mul_u32_u24 v12, 336, v10
  v_lshlrev_b32 v13, 4, v11
  v_add_u32 v223, v12, v13
  v_lshrrev_b32 v12, 5, v10
  v_mul_u32_u24 v12, 40960, v12
  v_and_b32 v10, 31, v10
  v_mul_u32_u24 v10, 81920, v10
  v_lshlrev_b32 v11, 3, v11
  v_add3_u32 v228, v10, v12, v11
  v_add_u32 v9, 1024, v8
  v_mul_lo_u32 v10, s50, v9
  v_lshrrev_b32 v10, 16, v10
  v_mul_u32_u24 v11, 20, v10
  v_sub_u32 v11, v9, v11
  v_mul_u32_u24 v12, 336, v10
  v_lshlrev_b32 v13, 4, v11
  v_add_u32 v224, v12, v13
  v_lshrrev_b32 v12, 5, v10
  v_mul_u32_u24 v12, 40960, v12
  v_and_b32 v10, 31, v10
  v_mul_u32_u24 v10, 81920, v10
  v_lshlrev_b32 v11, 3, v11
  v_add3_u32 v229, v10, v12, v11
  v_and_b32 v9, 15, v1
  v_mul_u32_u24 v9, 336, v9
  v_lshrrev_b32 v10, 4, v1
  v_lshlrev_b32 v10, 4, v10
  v_add_u32 v230, v9, v10
  s_add_u32 s50, s21, 2
  s_and_b32 s50, s50, 3
  s_lshl_b32 s50, s50, 3
  v_lshrrev_b32 v9, 4, v1
  v_lshlrev_b32 v9, 1, v9
  v_add_u32 v9, s50, v9
  s_mov_b32 s51, 0x3a000000
  s_mov_b32 s52, 0xba000000
  s_cmp_lt_u32 s73, 4
  s_cselect_b32 s52, s51, s52
  v_and_b32 v10, 15, v1
  v_lshlrev_b32 v10, 6, v10
  s_add_u32 s50, s21, 0
  s_and_b32 s50, s50, 3
  s_lshr_b32 s53, s50, 1
  s_lshl_b32 s53, s53, 5
  s_and_b32 s50, s50, 1
  s_lshl_b32 s50, s50, 10
  s_add_u32 s50, s50, s53
  s_add_u32 s50, s50, s72
  v_add_u32 v11, s50, v10
  v_add_u32 v12, 0, v9
  v_mul_u32_u24 v12, v11, v12
  v_and_b32 v12, 0x7ff, v12
  v_cvt_f32_u32 v12, v12
  v_mul_f32 v13, s51, v12
  v_mul_f32 v12, s52, v12
  v_cos_f32 v13, v13
  v_sin_f32 v12, v12
  s_nop 0
  v_cvt_pk_bf16_f32 v236, v13, v12
  v_add_u32 v12, 1, v9
  v_mul_u32_u24 v12, v11, v12
  v_and_b32 v12, 0x7ff, v12
  v_cvt_f32_u32 v12, v12
  v_mul_f32 v13, s51, v12
  v_mul_f32 v12, s52, v12
  v_cos_f32 v13, v13
  v_sin_f32 v12, v12
  s_nop 0
  v_cvt_pk_bf16_f32 v237, v13, v12
  v_add_u32 v12, 32, v9
  v_mul_u32_u24 v12, v11, v12
  v_and_b32 v12, 0x7ff, v12
  v_cvt_f32_u32 v12, v12
  v_mul_f32 v13, s51, v12
  v_mul_f32 v12, s52, v12
  v_cos_f32 v13, v13
  v_sin_f32 v12, v12
  s_nop 0
  v_cvt_pk_bf16_f32 v238, v13, v12
  v_add_u32 v12, 33, v9
  v_mul_u32_u24 v12, v11, v12
  v_and_b32 v12, 0x7ff, v12
  v_cvt_f32_u32 v12, v12
  v_mul_f32 v13, s51, v12
  v_mul_f32 v12, s52, v12
  v_cos_f32 v13, v13
  v_sin_f32 v12, v12
  s_nop 0
  v_cvt_pk_bf16_f32 v239, v13, v12
  s_add_u32 s50, s21, 1
  s_and_b32 s50, s50, 3
  s_lshr_b32 s53, s50, 1
  s_lshl_b32 s53, s53, 5
  s_and_b32 s50, s50, 1
  s_lshl_b32 s50, s50, 10
  s_add_u32 s50, s50, s53
  s_add_u32 s50, s50, s72
  v_add_u32 v11, s50, v10
  v_add_u32 v12, 0, v9
  v_mul_u32_u24 v12, v11, v12
  v_and_b32 v12, 0x7ff, v12
  v_cvt_f32_u32 v12, v12
  v_mul_f32 v13, s51, v12
  v_mul_f32 v12, s52, v12
  v_cos_f32 v13, v13
  v_sin_f32 v12, v12
  s_nop 0
  v_cvt_pk_bf16_f32 v240, v13, v12
  v_add_u32 v12, 1, v9
  v_mul_u32_u24 v12, v11, v12
  v_and_b32 v12, 0x7ff, v12
  v_cvt_f32_u32 v12, v12
  v_mul_f32 v13, s51, v12
  v_mul_f32 v12, s52, v12
  v_cos_f32 v13, v13
  v_sin_f32 v12, v12
  s_nop 0
  v_cvt_pk_bf16_f32 v241, v13, v12
  v_add_u32 v12, 32, v9
  v_mul_u32_u24 v12, v11, v12
  v_and_b32 v12, 0x7ff, v12
  v_cvt_f32_u32 v12, v12
  v_mul_f32 v13, s51, v12
  v_mul_f32 v12, s52, v12
  v_cos_f32 v13, v13
  v_sin_f32 v12, v12
  s_nop 0
  v_cvt_pk_bf16_f32 v242, v13, v12
  v_add_u32 v12, 33, v9
  v_mul_u32_u24 v12, v11, v12
  v_and_b32 v12, 0x7ff, v12
  v_cvt_f32_u32 v12, v12
  v_mul_f32 v13, s51, v12
  v_mul_f32 v12, s52, v12
  v_cos_f32 v13, v13
  v_sin_f32 v12, v12
  s_nop 0
  v_cvt_pk_bf16_f32 v243, v13, v12
  s_add_u32 s50, s21, 2
  s_and_b32 s50, s50, 3
  s_lshr_b32 s53, s50, 1
  s_lshl_b32 s53, s53, 5
  s_and_b32 s50, s50, 1
  s_lshl_b32 s50, s50, 10
  s_add_u32 s50, s50, s53
  s_add_u32 s50, s50, s72
  v_add_u32 v11, s50, v10
  v_add_u32 v12, 0, v9
  v_mul_u32_u24 v12, v11, v12
  v_and_b32 v12, 0x7ff, v12
  v_cvt_f32_u32 v12, v12
  v_mul_f32 v13, s51, v12
  v_mul_f32 v12, s52, v12
  v_cos_f32 v13, v13
  v_sin_f32 v12, v12
  s_nop 0
  v_cvt_pk_bf16_f32 v244, v13, v12
  v_add_u32 v12, 1, v9
  v_mul_u32_u24 v12, v11, v12
  v_and_b32 v12, 0x7ff, v12
  v_cvt_f32_u32 v12, v12
  v_mul_f32 v13, s51, v12
  v_mul_f32 v12, s52, v12
  v_cos_f32 v13, v13
  v_sin_f32 v12, v12
  s_nop 0
  v_cvt_pk_bf16_f32 v245, v13, v12
  v_add_u32 v12, 32, v9
  v_mul_u32_u24 v12, v11, v12
  v_and_b32 v12, 0x7ff, v12
  v_cvt_f32_u32 v12, v12
  v_mul_f32 v13, s51, v12
  v_mul_f32 v12, s52, v12
  v_cos_f32 v13, v13
  v_sin_f32 v12, v12
  s_nop 0
  v_cvt_pk_bf16_f32 v246, v13, v12
  v_add_u32 v12, 33, v9
  v_mul_u32_u24 v12, v11, v12
  v_and_b32 v12, 0x7ff, v12
  v_cvt_f32_u32 v12, v12
  v_mul_f32 v13, s51, v12
  v_mul_f32 v12, s52, v12
  v_cos_f32 v13, v13
  v_sin_f32 v12, v12
  s_nop 0
  v_cvt_pk_bf16_f32 v247, v13, v12
  s_add_u32 s50, s21, 3
  s_and_b32 s50, s50, 3
  s_lshr_b32 s53, s50, 1
  s_lshl_b32 s53, s53, 5
  s_and_b32 s50, s50, 1
  s_lshl_b32 s50, s50, 10
  s_add_u32 s50, s50, s53
  s_add_u32 s50, s50, s72
  v_add_u32 v11, s50, v10
  v_add_u32 v12, 0, v9
  v_mul_u32_u24 v12, v11, v12
  v_and_b32 v12, 0x7ff, v12
  v_cvt_f32_u32 v12, v12
  v_mul_f32 v13, s51, v12
  v_mul_f32 v12, s52, v12
  v_cos_f32 v13, v13
  v_sin_f32 v12, v12
  s_nop 0
  v_cvt_pk_bf16_f32 v248, v13, v12
  v_add_u32 v12, 1, v9
  v_mul_u32_u24 v12, v11, v12
  v_and_b32 v12, 0x7ff, v12
  v_cvt_f32_u32 v12, v12
  v_mul_f32 v13, s51, v12
  v_mul_f32 v12, s52, v12
  v_cos_f32 v13, v13
  v_sin_f32 v12, v12
  s_nop 0
  v_cvt_pk_bf16_f32 v249, v13, v12
  v_add_u32 v12, 32, v9
  v_mul_u32_u24 v12, v11, v12
  v_and_b32 v12, 0x7ff, v12
  v_cvt_f32_u32 v12, v12
  v_mul_f32 v13, s51, v12
  v_mul_f32 v12, s52, v12
  v_cos_f32 v13, v13
  v_sin_f32 v12, v12
  s_nop 0
  v_cvt_pk_bf16_f32 v250, v13, v12
  v_add_u32 v12, 33, v9
  v_mul_u32_u24 v12, v11, v12
  v_and_b32 v12, 0x7ff, v12
  v_cvt_f32_u32 v12, v12
  v_mul_f32 v13, s51, v12
  v_mul_f32 v12, s52, v12
  v_cos_f32 v13, v13
  v_sin_f32 v12, v12
  s_nop 0
  v_cvt_pk_bf16_f32 v251, v13, v12
  v_mov_b32 v16, 0
  v_mov_b32 v17, 0
  v_mov_b32 v18, 0
  v_mov_b32 v19, 0
  v_mov_b32 v20, 0
  v_mov_b32 v21, 0
  v_mov_b32 v22, 0
  v_mov_b32 v23, 0
  v_mov_b32 v24, 0
  v_mov_b32 v25, 0
  v_mov_b32 v26, 0
  v_mov_b32 v27, 0
  v_mov_b32 v28, 0
  v_mov_b32 v29, 0
  v_mov_b32 v30, 0
  v_mov_b32 v31, 0
  v_mov_b32 v32, 0
  v_mov_b32 v33, 0
  v_mov_b32 v34, 0
  v_mov_b32 v35, 0
  v_mov_b32 v36, 0
  v_mov_b32 v37, 0
  v_mov_b32 v38, 0
  v_mov_b32 v39, 0
  v_mov_b32 v40, 0
  v_mov_b32 v41, 0
  v_mov_b32 v42, 0
  v_mov_b32 v43, 0
  v_mov_b32 v44, 0
  v_mov_b32 v45, 0
  v_mov_b32 v46, 0
  v_mov_b32 v47, 0
  v_mov_b32 v48, 0
  v_mov_b32 v49, 0
  v_mov_b32 v50, 0
  v_mov_b32 v51, 0
  v_mov_b32 v52, 0
  v_mov_b32 v53, 0
  v_mov_b32 v54, 0
  v_mov_b32 v55, 0
  v_mov_b32 v56, 0
  v_mov_b32 v57, 0
  v_mov_b32 v58, 0
  v_mov_b32 v59, 0
  v_mov_b32 v60, 0
  v_mov_b32 v61, 0
  v_mov_b32 v62, 0
  v_mov_b32 v63, 0
  v_mov_b32 v64, 0
  v_mov_b32 v65, 0
  v_mov_b32 v66, 0
  v_mov_b32 v67, 0
  v_mov_b32 v68, 0
  v_mov_b32 v69, 0
  v_mov_b32 v70, 0
  v_mov_b32 v71, 0
  v_mov_b32 v72, 0
  v_mov_b32 v73, 0
  v_mov_b32 v74, 0
  v_mov_b32 v75, 0
  v_mov_b32 v76, 0
  v_mov_b32 v77, 0
  v_mov_b32 v78, 0
  v_mov_b32 v79, 0
  v_mov_b32 v80, 0
  v_mov_b32 v81, 0
  v_mov_b32 v82, 0
  v_mov_b32 v83, 0
  v_mov_b32 v84, 0
  v_mov_b32 v85, 0
  v_mov_b32 v86, 0
  v_mov_b32 v87, 0
  v_mov_b32 v88, 0
  v_mov_b32 v89, 0
  v_mov_b32 v90, 0
  v_mov_b32 v91, 0
  v_mov_b32 v92, 0
  v_mov_b32 v93, 0
  v_mov_b32 v94, 0
  v_mov_b32 v95, 0
  v_lshrrev_b32 v10, 4, v1
  v_mul_u32_u24 v10, 5248, v10
  v_and_b32 v11, 15, v1
  s_mul_i32 s50, s73, 80
  v_add_u32 v12, s50, v11
  v_sub_u32 v13, 576, v12
  s_cmp_lt_u32 s73, 4
  s_cselect_b64 s[60:61], -1, 0
  v_cndmask_b32 v12, v13, v12, s[60:61]
  v_lshlrev_b32 v12, 4, v12
  v_add_u32 v10, v10, v12
  s_sub_u32 s46, 32, s72
  s_and_b32 s46, s46, 31
  s_cmp_lt_u32 s73, 4
  s_cselect_b32 s46, s72, s46
  s_mul_i32 s46, s46, 83968
  s_add_u32 s46, s46, 9814016
  s_mov_b32 s47, 256
  s_mov_b32 s50, -256
  s_cmp_lt_u32 s73, 4
  s_cselect_b32 s47, s47, s50
  s_cselect_b32 s50, 0, 1024
  s_cselect_b32 s48, 0x80000000, 0
  s_add_u32 s46, s46, s50
  s_add_u32 s50, s21, 2
  s_and_b32 s50, s50, 3
  s_mul_i32 s50, s50, 20992
  s_add_u32 s46, s46, s50
  s_lshl_b32 s50, s73, 10
  s_add_u32 s50, s50, 12666880
  v_lshlrev_b32 v12, 3, v1
  v_add_u32 v12, s50, v12
  v_and_b32 v13, 15, v1
  v_lshlrev_b32 v13, 3, v13
  v_add_u32 v13, s50, v13
  v_add_u32 v13, 512, v13
  s_lshr_b32 s50, s72, 1
  s_lshl_b32 s50, s50, 7
  s_add_u32 s50, s50, 12664832
  v_min_u32 v9, 4, v1
  v_lshlrev_b32 v9, 3, v9
  v_add_u32 v9, s50, v9
  s_cmp_eq_u32 s21, 0
  s_cbranch_scc0 L_p2_lw
  s_waitcnt vmcnt(0)
L_p2_sp1:
  v_xor_b32 v215, s76, v215
  v_cmp_ne_u32 vcc, s75, v214
  v_cmp_lt_u32 s[60:61], 15, v215
  s_nop 3
  s_or_b64 vcc, vcc, s[60:61]
  s_cbranch_vccz L_p2_sp1_ok
  s_sub_u32 s74, s74, 1
  s_cmp_eq_u32 s74, 0
  s_cbranch_scc1 L_p2_sp1_ok
  s_sleep 4
  buffer_load_dwordx2 v[214:215], v15, s[24:27], 0 offen sc1
  s_waitcnt vmcnt(0)
  s_branch L_p2_sp1
L_p2_sp1_ok:
  v_mov_b32 v14, 157712
  v_mov_b32 v15, 1
  ds_write_b32 v14, v15
  s_waitcnt lgkmcnt(0)
  s_branch L_p2_go
L_p2_lw:
  v_mov_b32 v14, 157712
L_p2_lw1:
  ds_read_b32 v15, v14
  s_waitcnt lgkmcnt(0)
  s_nop 0
  v_readfirstlane_b32 s50, v15
  s_nop 3
  s_cmp_eq_u32 s50, 1
  s_cbranch_scc1 L_p2_go
  s_sleep 1
  s_sub_u32 s74, s74, 1
  s_cmp_eq_u32 s74, 0
  s_cbranch_scc0 L_p2_lw1
L_p2_go:
  s_lshl_b32 s50, s45, 10
  buffer_load_dwordx4 v[116:119], v4, s[28:31], s50 offen sc1
  buffer_load_dwordx4 v[120:123], v5, s[28:31], s50 offen sc1
  buffer_load_dwordx4 v[124:127], v6, s[28:31], s50 offen sc1
  buffer_load_dwordx4 v[128:131], v7, s[28:31], s50 offen sc1
  s_add_u32 s45, s45, 4
  s_cmp_ge_u32 s45, 54
  s_cselect_b32 s45, s21, s45
  s_lshl_b32 s50, s45, 10
  buffer_load_dwordx4 v[152:155], v4, s[28:31], s50 offen sc1
  buffer_load_dwordx4 v[156:159], v5, s[28:31], s50 offen sc1
  buffer_load_dwordx4 v[160:163], v6, s[28:31], s50 offen sc1
  buffer_load_dwordx4 v[164:167], v7, s[28:31], s50 offen sc1
  s_add_u32 s45, s45, 4
  s_cmp_ge_u32 s45, 54
  s_cselect_b32 s45, s21, s45
  s_lshl_b32 s50, s45, 10
  buffer_load_dwordx4 v[188:191], v4, s[28:31], s50 offen sc1
  buffer_load_dwordx4 v[192:195], v5, s[28:31], s50 offen sc1
  buffer_load_dwordx4 v[196:199], v6, s[28:31], s50 offen sc1
  buffer_load_dwordx4 v[200:203], v7, s[28:31], s50 offen sc1
  s_add_u32 s45, s45, 4
  s_cmp_ge_u32 s45, 54
  s_cselect_b32 s45, s21, s45
  s_waitcnt vmcnt(8)
  v_mfma_f32_16x16x32_bf16 v[16:19], v[96:99], v[116:119], v[16:19]
  v_mfma_f32_16x16x32_bf16 v[32:35], v[100:103], v[116:119], v[32:35]
  v_mfma_f32_16x16x32_bf16 v[48:51], v[104:107], v[116:119], v[48:51]
  v_mfma_f32_16x16x32_bf16 v[64:67], v[108:111], v[116:119], v[64:67]
  v_mfma_f32_16x16x32_bf16 v[80:83], v[112:115], v[116:119], v[80:83]
  v_mfma_f32_16x16x32_bf16 v[20:23], v[96:99], v[120:123], v[20:23]
  v_mfma_f32_16x16x32_bf16 v[36:39], v[100:103], v[120:123], v[36:39]
  v_mfma_f32_16x16x32_bf16 v[52:55], v[104:107], v[120:123], v[52:55]
  v_mfma_f32_16x16x32_bf16 v[68:71], v[108:111], v[120:123], v[68:71]
  v_mfma_f32_16x16x32_bf16 v[84:87], v[112:115], v[120:123], v[84:87]
  v_mfma_f32_16x16x32_bf16 v[24:27], v[96:99], v[124:127], v[24:27]
  v_mfma_f32_16x16x32_bf16 v[40:43], v[100:103], v[124:127], v[40:43]
  v_mfma_f32_16x16x32_bf16 v[56:59], v[104:107], v[124:127], v[56:59]
  v_mfma_f32_16x16x32_bf16 v[72:75], v[108:111], v[124:127], v[72:75]
  v_mfma_f32_16x16x32_bf16 v[88:91], v[112:115], v[124:127], v[88:91]
  v_mfma_f32_16x16x32_bf16 v[28:31], v[96:99], v[128:131], v[28:31]
  v_mfma_f32_16x16x32_bf16 v[44:47], v[100:103], v[128:131], v[44:47]
  v_mfma_f32_16x16x32_bf16 v[60:63], v[104:107], v[128:131], v[60:63]
  v_mfma_f32_16x16x32_bf16 v[76:79], v[108:111], v[128:131], v[76:79]
  v_mfma_f32_16x16x32_bf16 v[92:95], v[112:115], v[128:131], v[92:95]
  s_mul_i32 s50, s44, 5120
  s_add_u32 s50, s50, s49
  buffer_load_dwordx4 v[96:99], v2, s[24:27], s50 offen offset:0 sc1
  buffer_load_dwordx4 v[100:103], v2, s[24:27], s50 offen offset:1024 sc1
  buffer_load_dwordx4 v[104:107], v2, s[24:27], s50 offen offset:2048 sc1
  buffer_load_dwordx4 v[108:111], v2, s[24:27], s50 offen offset:3072 sc1
  buffer_load_dwordx4 v[112:115], v3, s[24:27], s50 offen sc1
  s_add_u32 s44, s44, 4
  s_cmp_ge_u32 s44, 54
  s_cselect_b32 s44, s21, s44
  s_lshl_b32 s50, s45, 10
  buffer_load_dwordx4 v[116:119], v4, s[28:31], s50 offen sc1
  buffer_load_dwordx4 v[120:123], v5, s[28:31], s50 offen sc1
  buffer_load_dwordx4 v[124:127], v6, s[28:31], s50 offen sc1
  buffer_load_dwordx4 v[128:131], v7, s[28:31], s50 offen sc1
  s_add_u32 s45, s45, 4
  s_cmp_ge_u32 s45, 54
  s_cselect_b32 s45, s21, s45
  s_waitcnt vmcnt(13)
  v_mfma_f32_16x16x32_bf16 v[16:19], v[132:135], v[152:155], v[16:19]
  v_mfma_f32_16x16x32_bf16 v[32:35], v[136:139], v[152:155], v[32:35]
  v_mfma_f32_16x16x32_bf16 v[48:51], v[140:143], v[152:155], v[48:51]
  v_mfma_f32_16x16x32_bf16 v[64:67], v[144:147], v[152:155], v[64:67]
  v_mfma_f32_16x16x32_bf16 v[80:83], v[148:151], v[152:155], v[80:83]
  v_mfma_f32_16x16x32_bf16 v[20:23], v[132:135], v[156:159], v[20:23]
  v_mfma_f32_16x16x32_bf16 v[36:39], v[136:139], v[156:159], v[36:39]
  v_mfma_f32_16x16x32_bf16 v[52:55], v[140:143], v[156:159], v[52:55]
  v_mfma_f32_16x16x32_bf16 v[68:71], v[144:147], v[156:159], v[68:71]
  v_mfma_f32_16x16x32_bf16 v[84:87], v[148:151], v[156:159], v[84:87]
  v_mfma_f32_16x16x32_bf16 v[24:27], v[132:135], v[160:163], v[24:27]
  v_mfma_f32_16x16x32_bf16 v[40:43], v[136:139], v[160:163], v[40:43]
  v_mfma_f32_16x16x32_bf16 v[56:59], v[140:143], v[160:163], v[56:59]
  v_mfma_f32_16x16x32_bf16 v[72:75], v[144:147], v[160:163], v[72:75]
  v_mfma_f32_16x16x32_bf16 v[88:91], v[148:151], v[160:163], v[88:91]
  v_mfma_f32_16x16x32_bf16 v[28:31], v[132:135], v[164:167], v[28:31]
  v_mfma_f32_16x16x32_bf16 v[44:47], v[136:139], v[164:167], v[44:47]
  v_mfma_f32_16x16x32_bf16 v[60:63], v[140:143], v[164:167], v[60:63]
  v_mfma_f32_16x16x32_bf16 v[76:79], v[144:147], v[164:167], v[76:79]
  v_mfma_f32_16x16x32_bf16 v[92:95], v[148:151], v[164:167], v[92:95]
  s_mul_i32 s50, s44, 5120
  s_add_u32 s50, s50, s49
  buffer_load_dwordx4 v[132:135], v2, s[24:27], s50 offen offset:0 sc1
  buffer_load_dwordx4 v[136:139], v2, s[24:27], s50 offen offset:1024 sc1
  buffer_load_dwordx4 v[140:143], v2, s[24:27], s50 offen offset:2048 sc1
  buffer_load_dwordx4 v[144:147], v2, s[24:27], s50 offen offset:3072 sc1
  buffer_load_dwordx4 v[148:151], v3, s[24:27], s50 offen sc1
  s_add_u32 s44, s44, 4
  s_cmp_ge_u32 s44, 54
  s_cselect_b32 s44, s21, s44
  s_lshl_b32 s50, s45, 10
  buffer_load_dwordx4 v[152:155], v4, s[28:31], s50 offen sc1
  buffer_load_dwordx4 v[156:159], v5, s[28:31], s50 offen sc1
  buffer_load_dwordx4 v[160:163], v6, s[28:31], s50 offen sc1
  buffer_load_dwordx4 v[164:167], v7, s[28:31], s50 offen sc1
  s_add_u32 s45, s45, 4
  s_cmp_ge_u32 s45, 54
  s_cselect_b32 s45, s21, s45
  s_waitcnt vmcnt(18)
  v_mfma_f32_16x16x32_bf16 v[16:19], v[168:171], v[188:191], v[16:19]
  v_mfma_f32_16x16x32_bf16 v[32:35], v[172:175], v[188:191], v[32:35]
  v_mfma_f32_16x16x32_bf16 v[48:51], v[176:179], v[188:191], v[48:51]
  v_mfma_f32_16x16x32_bf16 v[64:67], v[180:183], v[188:191], v[64:67]
  v_mfma_f32_16x16x32_bf16 v[80:83], v[184:187], v[188:191], v[80:83]
  v_mfma_f32_16x16x32_bf16 v[20:23], v[168:171], v[192:195], v[20:23]
  v_mfma_f32_16x16x32_bf16 v[36:39], v[172:175], v[192:195], v[36:39]
  v_mfma_f32_16x16x32_bf16 v[52:55], v[176:179], v[192:195], v[52:55]
  v_mfma_f32_16x16x32_bf16 v[68:71], v[180:183], v[192:195], v[68:71]
  v_mfma_f32_16x16x32_bf16 v[84:87], v[184:187], v[192:195], v[84:87]
  v_mfma_f32_16x16x32_bf16 v[24:27], v[168:171], v[196:199], v[24:27]
  v_mfma_f32_16x16x32_bf16 v[40:43], v[172:175], v[196:199], v[40:43]
  v_mfma_f32_16x16x32_bf16 v[56:59], v[176:179], v[196:199], v[56:59]
  v_mfma_f32_16x16x32_bf16 v[72:75], v[180:183], v[196:199], v[72:75]
  v_mfma_f32_16x16x32_bf16 v[88:91], v[184:187], v[196:199], v[88:91]
  v_mfma_f32_16x16x32_bf16 v[28:31], v[168:171], v[200:203], v[28:31]
  v_mfma_f32_16x16x32_bf16 v[44:47], v[172:175], v[200:203], v[44:47]
  v_mfma_f32_16x16x32_bf16 v[60:63], v[176:179], v[200:203], v[60:63]
  v_mfma_f32_16x16x32_bf16 v[76:79], v[180:183], v[200:203], v[76:79]
  v_mfma_f32_16x16x32_bf16 v[92:95], v[184:187], v[200:203], v[92:95]
  s_mul_i32 s50, s44, 5120
  s_add_u32 s50, s50, s49
  buffer_load_dwordx4 v[168:171], v2, s[24:27], s50 offen offset:0 sc1
  buffer_load_dwordx4 v[172:175], v2, s[24:27], s50 offen offset:1024 sc1
  buffer_load_dwordx4 v[176:179], v2, s[24:27], s50 offen offset:2048 sc1
  buffer_load_dwordx4 v[180:183], v2, s[24:27], s50 offen offset:3072 sc1
  buffer_load_dwordx4 v[184:187], v3, s[24:27], s50 offen sc1
  s_add_u32 s44, s44, 4
  s_cmp_ge_u32 s44, 54
  s_cselect_b32 s44, s21, s44
  s_lshl_b32 s50, s45, 10
  buffer_load_dwordx4 v[188:191], v4, s[28:31], s50 offen sc1
  buffer_load_dwordx4 v[192:195], v5, s[28:31], s50 offen sc1
  buffer_load_dwordx4 v[196:199], v6, s[28:31], s50 offen sc1
  buffer_load_dwordx4 v[200:203], v7, s[28:31], s50 offen sc1
  s_add_u32 s45, s45, 4
  s_cmp_ge_u32 s45, 54
  s_cselect_b32 s45, s21, s45
  buffer_load_dwordx2 v[218:219], v9, s[24:27], 0 offen sc1
  s_mov_b32 s51, 2
L_p2_loop:
  s_waitcnt vmcnt(18)
  v_mfma_f32_16x16x32_bf16 v[16:19], v[96:99], v[116:119], v[16:19]
  v_mfma_f32_16x16x32_bf16 v[32:35], v[100:103], v[116:119], v[32:35]
  v_mfma_f32_16x16x32_bf16 v[48:51], v[104:107], v[116:119], v[48:51]
  v_mfma_f32_16x16x32_bf16 v[64:67], v[108:111], v[116:119], v[64:67]
  v_mfma_f32_16x16x32_bf16 v[80:83], v[112:115], v[116:119], v[80:83]
  v_mfma_f32_16x16x32_bf16 v[20:23], v[96:99], v[120:123], v[20:23]
  v_mfma_f32_16x16x32_bf16 v[36:39], v[100:103], v[120:123], v[36:39]
  v_mfma_f32_16x16x32_bf16 v[52:55], v[104:107], v[120:123], v[52:55]
  v_mfma_f32_16x16x32_bf16 v[68:71], v[108:111], v[120:123], v[68:71]
  v_mfma_f32_16x16x32_bf16 v[84:87], v[112:115], v[120:123], v[84:87]
  v_mfma_f32_16x16x32_bf16 v[24:27], v[96:99], v[124:127], v[24:27]
  v_mfma_f32_16x16x32_bf16 v[40:43], v[100:103], v[124:127], v[40:43]
  v_mfma_f32_16x16x32_bf16 v[56:59], v[104:107], v[124:127], v[56:59]
  v_mfma_f32_16x16x32_bf16 v[72:75], v[108:111], v[124:127], v[72:75]
  v_mfma_f32_16x16x32_bf16 v[88:91], v[112:115], v[124:127], v[88:91]
  v_mfma_f32_16x16x32_bf16 v[28:31], v[96:99], v[128:131], v[28:31]
  v_mfma_f32_16x16x32_bf16 v[44:47], v[100:103], v[128:131], v[44:47]
  v_mfma_f32_16x16x32_bf16 v[60:63], v[104:107], v[128:131], v[60:63]
  v_mfma_f32_16x16x32_bf16 v[76:79], v[108:111], v[128:131], v[76:79]
  v_mfma_f32_16x16x32_bf16 v[92:95], v[112:115], v[128:131], v[92:95]
  s_mul_i32 s50, s44, 5120
  s_add_u32 s50, s50, s49
  buffer_load_dwordx4 v[96:99], v2, s[24:27], s50 offen offset:0 sc1
  buffer_load_dwordx4 v[100:103], v2, s[24:27], s50 offen offset:1024 sc1
  buffer_load_dwordx4 v[104:107], v2, s[24:27], s50 offen offset:2048 sc1
  buffer_load_dwordx4 v[108:111], v2, s[24:27], s50 offen offset:3072 sc1
  buffer_load_dwordx4 v[112:115], v3, s[24:27], s50 offen sc1
  s_add_u32 s44, s44, 4
  s_cmp_ge_u32 s44, 54
  s_cselect_b32 s44, s21, s44
  s_lshl_b32 s50, s45, 10
  buffer_load_dwordx4 v[116:119], v4, s[28:31], s50 offen sc1
  buffer_load_dwordx4 v[120:123], v5, s[28:31], s50 offen sc1
  buffer_load_dwordx4 v[124:127], v6, s[28:31], s50 offen sc1
  buffer_load_dwordx4 v[128:131], v7, s[28:31], s50 offen sc1
  s_add_u32 s45, s45, 4
  s_cmp_ge_u32 s45, 54
  s_cselect_b32 s45, s21, s45
  s_waitcnt vmcnt(18)
  v_mfma_f32_16x16x32_bf16 v[16:19], v[132:135], v[152:155], v[16:19]
  v_mfma_f32_16x16x32_bf16 v[32:35], v[136:139], v[152:155], v[32:35]
  v_mfma_f32_16x16x32_bf16 v[48:51], v[140:143], v[152:155], v[48:51]
  v_mfma_f32_16x16x32_bf16 v[64:67], v[144:147], v[152:155], v[64:67]
  v_mfma_f32_16x16x32_bf16 v[80:83], v[148:151], v[152:155], v[80:83]
  v_mfma_f32_16x16x32_bf16 v[20:23], v[132:135], v[156:159], v[20:23]
  v_mfma_f32_16x16x32_bf16 v[36:39], v[136:139], v[156:159], v[36:39]
  v_mfma_f32_16x16x32_bf16 v[52:55], v[140:143], v[156:159], v[52:55]
  v_mfma_f32_16x16x32_bf16 v[68:71], v[144:147], v[156:159], v[68:71]
  v_mfma_f32_16x16x32_bf16 v[84:87], v[148:151], v[156:159], v[84:87]
  v_mfma_f32_16x16x32_bf16 v[24:27], v[132:135], v[160:163], v[24:27]
  v_mfma_f32_16x16x32_bf16 v[40:43], v[136:139], v[160:163], v[40:43]
  v_mfma_f32_16x16x32_bf16 v[56:59], v[140:143], v[160:163], v[56:59]
  v_mfma_f32_16x16x32_bf16 v[72:75], v[144:147], v[160:163], v[72:75]
  v_mfma_f32_16x16x32_bf16 v[88:91], v[148:151], v[160:163], v[88:91]
  v_mfma_f32_16x16x32_bf16 v[28:31], v[132:135], v[164:167], v[28:31]
  v_mfma_f32_16x16x32_bf16 v[44:47], v[136:139], v[164:167], v[44:47]
  v_mfma_f32_16x16x32_bf16 v[60:63], v[140:143], v[164:167], v[60:63]
  v_mfma_f32_16x16x32_bf16 v[76:79], v[144:147], v[164:167], v[76:79]
  v_mfma_f32_16x16x32_bf16 v[92:95], v[148:151], v[164:167], v[92:95]
  s_mul_i32 s50, s44, 5120
  s_add_u32 s50, s50, s49
  buffer_load_dwordx4 v[132:135], v2, s[24:27], s50 offen offset:0 sc1
  buffer_load_dwordx4 v[136:139], v2, s[24:27], s50 offen offset:1024 sc1
  buffer_load_dwordx4 v[140:143], v2, s[24:27], s50 offen offset:2048 sc1
  buffer_load_dwordx4 v[144:147], v2, s[24:27], s50 offen offset:3072 sc1
  buffer_load_dwordx4 v[148:151], v3, s[24:27], s50 offen sc1
  s_add_u32 s44, s44, 4
  s_cmp_ge_u32 s44, 54
  s_cselect_b32 s44, s21, s44
  s_lshl_b32 s50, s45, 10
  buffer_load_dwordx4 v[152:155], v4, s[28:31], s50 offen sc1
  buffer_load_dwordx4 v[156:159], v5, s[28:31], s50 offen sc1
  buffer_load_dwordx4 v[160:163], v6, s[28:31], s50 offen sc1
  buffer_load_dwordx4 v[164:167], v7, s[28:31], s50 offen sc1
  s_add_u32 s45, s45, 4
  s_cmp_ge_u32 s45, 54
  s_cselect_b32 s45, s21, s45
  s_waitcnt vmcnt(18)
  v_mfma_f32_16x16x32_bf16 v[16:19], v[168:171], v[188:191], v[16:19]
  v_mfma_f32_16x16x32_bf16 v[32:35], v[172:175], v[188:191], v[32:35]
  v_mfma_f32_16x16x32_bf16 v[48:51], v[176:179], v[188:191], v[48:51]
  v_mfma_f32_16x16x32_bf16 v[64:67], v[180:183], v[188:191], v[64:67]
  v_mfma_f32_16x16x32_bf16 v[80:83], v[184:187], v[188:191], v[80:83]
  v_mfma_f32_16x16x32_bf16 v[20:23], v[168:171], v[192:195], v[20:23]
  v_mfma_f32_16x16x32_bf16 v[36:39], v[172:175], v[192:195], v[36:39]
  v_mfma_f32_16x16x32_bf16 v[52:55], v[176:179], v[192:195], v[52:55]
  v_mfma_f32_16x16x32_bf16 v[68:71], v[180:183], v[192:195], v[68:71]
  v_mfma_f32_16x16x32_bf16 v[84:87], v[184:187], v[192:195], v[84:87]
  v_mfma_f32_16x16x32_bf16 v[24:27], v[168:171], v[196:199], v[24:27]
  v_mfma_f32_16x16x32_bf16 v[40:43], v[172:175], v[196:199], v[40:43]
  v_mfma_f32_16x16x32_bf16 v[56:59], v[176:179], v[196:199], v[56:59]
  v_mfma_f32_16x16x32_bf16 v[72:75], v[180:183], v[196:199], v[72:75]
  v_mfma_f32_16x16x32_bf16 v[88:91], v[184:187], v[196:199], v[88:91]
  v_mfma_f32_16x16x32_bf16 v[28:31], v[168:171], v[200:203], v[28:31]
  v_mfma_f32_16x16x32_bf16 v[44:47], v[172:175], v[200:203], v[44:47]
  v_mfma_f32_16x16x32_bf16 v[60:63], v[176:179], v[200:203], v[60:63]
  v_mfma_f32_16x16x32_bf16 v[76:79], v[180:183], v[200:203], v[76:79]
  v_mfma_f32_16x16x32_bf16 v[92:95], v[184:187], v[200:203], v[92:95]
  s_mul_i32 s50, s44, 5120
  s_add_u32 s50, s50, s49
  buffer_load_dwordx4 v[168:171], v2, s[24:27], s50 offen offset:0 sc1
  buffer_load_dwordx4 v[172:175], v2, s[24:27], s50 offen offset:1024 sc1
  buffer_load_dwordx4 v[176:179], v2, s[24:27], s50 offen offset:2048 sc1
  buffer_load_dwordx4 v[180:183], v2, s[24:27], s50 offen offset:3072 sc1
  buffer_load_dwordx4 v[184:187], v3, s[24:27], s50 offen sc1
  s_add_u32 s44, s44, 4
  s_cmp_ge_u32 s44, 54
  s_cselect_b32 s44, s21, s44
  s_lshl_b32 s50, s45, 10
  buffer_load_dwordx4 v[188:191], v4, s[28:31], s50 offen sc1
  buffer_load_dwordx4 v[192:195], v5, s[28:31], s50 offen sc1
  buffer_load_dwordx4 v[196:199], v6, s[28:31], s50 offen sc1
  buffer_load_dwordx4 v[200:203], v7, s[28:31], s50 offen sc1
  s_add_u32 s45, s45, 4
  s_cmp_ge_u32 s45, 54
  s_cselect_b32 s45, s21, s45
  s_cmp_eq_u32 s51, 2
  s_cbranch_scc0 L_p2_nt
L_p2_spm:
  v_xor_b32 v219, s76, v219
  v_cmp_ne_u32 vcc, s75, v218
  v_cmp_lt_u32 s[60:61], 15, v219
  s_nop 3
  s_or_b64 vcc, vcc, s[60:61]
  s_cbranch_vccz L_p2_spm_ok
  s_sub_u32 s74, s74, 1
  s_cmp_eq_u32 s74, 0
  s_cbranch_scc1 L_p2_spm_ok
  s_sleep 4
  buffer_load_dwordx2 v[218:219], v9, s[24:27], 0 offen sc1
  s_waitcnt vmcnt(0)
  s_branch L_p2_spm
L_p2_spm_ok:
L_p2_nt:
  s_sub_u32 s51, s51, 1
  s_cmp_lg_u32 s51, 0
  s_cbranch_scc1 L_p2_loop
  buffer_load_dwordx2 v[214:215], v12, s[24:27], 0 offen sc1
  buffer_load_dwordx2 v[216:217], v13, s[24:27], 0 offen sc1
  s_waitcnt vmcnt(18)
  v_mfma_f32_16x16x32_bf16 v[16:19], v[96:99], v[116:119], v[16:19]
  v_mfma_f32_16x16x32_bf16 v[32:35], v[100:103], v[116:119], v[32:35]
  v_mfma_f32_16x16x32_bf16 v[48:51], v[104:107], v[116:119], v[48:51]
  v_mfma_f32_16x16x32_bf16 v[64:67], v[108:111], v[116:119], v[64:67]
  v_mfma_f32_16x16x32_bf16 v[80:83], v[112:115], v[116:119], v[80:83]
  v_mfma_f32_16x16x32_bf16 v[20:23], v[96:99], v[120:123], v[20:23]
  v_mfma_f32_16x16x32_bf16 v[36:39], v[100:103], v[120:123], v[36:39]
  v_mfma_f32_16x16x32_bf16 v[52:55], v[104:107], v[120:123], v[52:55]
  v_mfma_f32_16x16x32_bf16 v[68:71], v[108:111], v[120:123], v[68:71]
  v_mfma_f32_16x16x32_bf16 v[84:87], v[112:115], v[120:123], v[84:87]
  v_mfma_f32_16x16x32_bf16 v[24:27], v[96:99], v[124:127], v[24:27]
  v_mfma_f32_16x16x32_bf16 v[40:43], v[100:103], v[124:127], v[40:43]
  v_mfma_f32_16x16x32_bf16 v[56:59], v[104:107], v[124:127], v[56:59]
  v_mfma_f32_16x16x32_bf16 v[72:75], v[108:111], v[124:127], v[72:75]
  v_mfma_f32_16x16x32_bf16 v[88:91], v[112:115], v[124:127], v[88:91]
  v_mfma_f32_16x16x32_bf16 v[28:31], v[96:99], v[128:131], v[28:31]
  v_mfma_f32_16x16x32_bf16 v[44:47], v[100:103], v[128:131], v[44:47]
  v_mfma_f32_16x16x32_bf16 v[60:63], v[104:107], v[128:131], v[60:63]
  v_mfma_f32_16x16x32_bf16 v[76:79], v[108:111], v[128:131], v[76:79]
  v_mfma_f32_16x16x32_bf16 v[92:95], v[112:115], v[128:131], v[92:95]
  s_mul_i32 s50, s44, 5120
  s_add_u32 s50, s50, s49
  buffer_load_dwordx4 v[96:99], v2, s[24:27], s50 offen offset:0 sc1
  buffer_load_dwordx4 v[100:103], v2, s[24:27], s50 offen offset:1024 sc1
  buffer_load_dwordx4 v[104:107], v2, s[24:27], s50 offen offset:2048 sc1
  buffer_load_dwordx4 v[108:111], v2, s[24:27], s50 offen offset:3072 sc1
  buffer_load_dwordx4 v[112:115], v3, s[24:27], s50 offen sc1
  s_add_u32 s44, s44, 4
  s_cmp_ge_u32 s44, 54
  s_cselect_b32 s44, s21, s44
  s_lshl_b32 s50, s45, 10
  buffer_load_dwordx4 v[116:119], v4, s[28:31], s50 offen sc1
  buffer_load_dwordx4 v[120:123], v5, s[28:31], s50 offen sc1
  buffer_load_dwordx4 v[124:127], v6, s[28:31], s50 offen sc1
  buffer_load_dwordx4 v[128:131], v7, s[28:31], s50 offen sc1
  s_add_u32 s45, s45, 4
  s_cmp_ge_u32 s45, 54
  s_cselect_b32 s45, s21, s45
  s_cmp_lt_u32 s21, 2
  s_cbranch_scc0 L_p2_hi
  s_waitcnt vmcnt(18)
  v_mfma_f32_16x16x32_bf16 v[16:19], v[132:135], v[152:155], v[16:19]
  v_mfma_f32_16x16x32_bf16 v[32:35], v[136:139], v[152:155], v[32:35]
  v_mfma_f32_16x16x32_bf16 v[48:51], v[140:143], v[152:155], v[48:51]
  v_mfma_f32_16x16x32_bf16 v[64:67], v[144:147], v[152:155], v[64:67]
  v_mfma_f32_16x16x32_bf16 v[80:83], v[148:151], v[152:155], v[80:83]
  v_mfma_f32_16x16x32_bf16 v[20:23], v[132:135], v[156:159], v[20:23]
  v_mfma_f32_16x16x32_bf16 v[36:39], v[136:139], v[156:159], v[36:39]
  v_mfma_f32_16x16x32_bf16 v[52:55], v[140:143], v[156:159], v[52:55]
  v_mfma_f32_16x16x32_bf16 v[68:71], v[144:147], v[156:159], v[68:71]
  v_mfma_f32_16x16x32_bf16 v[84:87], v[148:151], v[156:159], v[84:87]
  v_mfma_f32_16x16x32_bf16 v[24:27], v[132:135], v[160:163], v[24:27]
  v_mfma_f32_16x16x32_bf16 v[40:43], v[136:139], v[160:163], v[40:43]
  v_mfma_f32_16x16x32_bf16 v[56:59], v[140:143], v[160:163], v[56:59]
  v_mfma_f32_16x16x32_bf16 v[72:75], v[144:147], v[160:163], v[72:75]
  v_mfma_f32_16x16x32_bf16 v[88:91], v[148:151], v[160:163], v[88:91]
  v_mfma_f32_16x16x32_bf16 v[28:31], v[132:135], v[164:167], v[28:31]
  v_mfma_f32_16x16x32_bf16 v[44:47], v[136:139], v[164:167], v[44:47]
  v_mfma_f32_16x16x32_bf16 v[60:63], v[140:143], v[164:167], v[60:63]
  v_mfma_f32_16x16x32_bf16 v[76:79], v[144:147], v[164:167], v[76:79]
  v_mfma_f32_16x16x32_bf16 v[92:95], v[148:151], v[164:167], v[92:95]
  s_mul_i32 s50, s44, 5120
  s_add_u32 s50, s50, s49
  buffer_load_dwordx4 v[132:135], v2, s[24:27], s50 offen offset:0 sc1
  buffer_load_dwordx4 v[136:139], v2, s[24:27], s50 offen offset:1024 sc1
  buffer_load_dwordx4 v[140:143], v2, s[24:27], s50 offen offset:2048 sc1
  buffer_load_dwordx4 v[144:147], v2, s[24:27], s50 offen offset:3072 sc1
  buffer_load_dwordx4 v[148:151], v3, s[24:27], s50 offen sc1
  s_add_u32 s44, s44, 4
  s_cmp_ge_u32 s44, 54
  s_cselect_b32 s44, s21, s44
  s_lshl_b32 s50, s45, 10
  buffer_load_dwordx4 v[152:155], v4, s[28:31], s50 offen sc1
  buffer_load_dwordx4 v[156:159], v5, s[28:31], s50 offen sc1
  buffer_load_dwordx4 v[160:163], v6, s[28:31], s50 offen sc1
  buffer_load_dwordx4 v[164:167], v7, s[28:31], s50 offen sc1
  s_add_u32 s45, s45, 4
  s_cmp_ge_u32 s45, 54
  s_cselect_b32 s45, s21, s45
  s_waitcnt vmcnt(18)
  v_mfma_f32_16x16x32_bf16 v[16:19], v[168:171], v[188:191], v[16:19]
  v_mfma_f32_16x16x32_bf16 v[32:35], v[172:175], v[188:191], v[32:35]
  v_mfma_f32_16x16x32_bf16 v[48:51], v[176:179], v[188:191], v[48:51]
  v_mfma_f32_16x16x32_bf16 v[64:67], v[180:183], v[188:191], v[64:67]
  v_mfma_f32_16x16x32_bf16 v[80:83], v[184:187], v[188:191], v[80:83]
  v_mfma_f32_16x16x32_bf16 v[20:23], v[168:171], v[192:195], v[20:23]
  v_mfma_f32_16x16x32_bf16 v[36:39], v[172:175], v[192:195], v[36:39]
  v_mfma_f32_16x16x32_bf16 v[52:55], v[176:179], v[192:195], v[52:55]
  v_mfma_f32_16x16x32_bf16 v[68:71], v[180:183], v[192:195], v[68:71]
  v_mfma_f32_16x16x32_bf16 v[84:87], v[184:187], v[192:195], v[84:87]
  v_mfma_f32_16x16x32_bf16 v[24:27], v[168:171], v[196:199], v[24:27]
  v_mfma_f32_16x16x32_bf16 v[40:43], v[172:175], v[196:199], v[40:43]
  v_mfma_f32_16x16x32_bf16 v[56:59], v[176:179], v[196:199], v[56:59]
  v_mfma_f32_16x16x32_bf16 v[72:75], v[180:183], v[196:199], v[72:75]
  v_mfma_f32_16x16x32_bf16 v[88:91], v[184:187], v[196:199], v[88:91]
  v_mfma_f32_16x16x32_bf16 v[28:31], v[168:171], v[200:203], v[28:31]
  v_mfma_f32_16x16x32_bf16 v[44:47], v[172:175], v[200:203], v[44:47]
  v_mfma_f32_16x16x32_bf16 v[60:63], v[176:179], v[200:203], v[60:63]
  v_mfma_f32_16x16x32_bf16 v[76:79], v[180:183], v[200:203], v[76:79]
  v_mfma_f32_16x16x32_bf16 v[92:95], v[184:187], v[200:203], v[92:95]
L_p2_lo2:
  v_cmp_ne_u32 vcc, s75, v214
  v_cmp_ne_u32 s[60:61], s76, v215
  s_nop 3
  s_or_b64 vcc, vcc, s[60:61]
  s_cbranch_vccz L_p2_lo2_ok
  s_sub_u32 s74, s74, 1
  s_cmp_eq_u32 s74, 0
  s_cbranch_scc1 L_p2_lo2_ok
  s_sleep 4
  buffer_load_dwordx2 v[214:215], v12, s[24:27], 0 offen sc1
  s_waitcnt vmcnt(0)
  s_branch L_p2_lo2
L_p2_lo2_ok:
L_p2_lo3:
  v_cmp_ne_u32 vcc, s75, v216
  v_cmp_ne_u32 s[60:61], s76, v217
  s_nop 3
  s_or_b64 vcc, vcc, s[60:61]
  s_cbranch_vccz L_p2_lo3_ok
  s_sub_u32 s74, s74, 1
  s_cmp_eq_u32 s74, 0
  s_cbranch_scc1 L_p2_lo3_ok
  s_sleep 4
  buffer_load_dwordx2 v[216:217], v13, s[24:27], 0 offen sc1
  s_waitcnt vmcnt(0)
  s_branch L_p2_lo3
L_p2_lo3_ok:
  s_cmp_eq_u32 s2, 0
  s_cbranch_scc0 L_p2_lo_noep
  s_cmp_eq_u32 s21, 0
  s_cbranch_scc0 L_p2_lo_noep
  v_mov_b32 v14, s75
  v_mov_b32 v15, 12648448
  s_mov_b64 exec, 1
  buffer_store_dword v14, v15, s[24:27], 0 offen sc1
  s_mov_b64 exec, -1
L_p2_lo_noep:
  s_mov_b32 s50, s46
  buffer_load_dwordx4 v[168:171], v10, s[24:27], s50 offen sc1
  s_add_u32 s50, s50, s47
  buffer_load_dwordx4 v[172:175], v10, s[24:27], s50 offen sc1
  s_add_u32 s50, s50, s47
  buffer_load_dwordx4 v[176:179], v10, s[24:27], s50 offen sc1
  s_add_u32 s50, s50, s47
  buffer_load_dwordx4 v[180:183], v10, s[24:27], s50 offen sc1
  s_add_u32 s50, s50, s47
  buffer_load_dwordx4 v[184:187], v10, s[24:27], s50 offen sc1
  buffer_load_dwordx2 v[204:205], v225, s[32:35], s38 offen
  buffer_load_dwordx2 v[206:207], v226, s[32:35], s38 offen
  buffer_load_dwordx2 v[208:209], v227, s[32:35], s38 offen
  buffer_load_dwordx2 v[210:211], v228, s[32:35], s38 offen
  buffer_load_dwordx2 v[212:213], v229, s[32:35], s38 offen
  s_waitcnt vmcnt(19)
  v_mfma_f32_16x16x32_bf16 v[16:19], v[96:99], v[116:119], v[16:19]
  v_mfma_f32_16x16x32_bf16 v[32:35], v[100:103], v[116:119], v[32:35]
  v_mfma_f32_16x16x32_bf16 v[48:51], v[104:107], v[116:119], v[48:51]
  v_mfma_f32_16x16x32_bf16 v[64:67], v[108:111], v[116:119], v[64:67]
  v_mfma_f32_16x16x32_bf16 v[80:83], v[112:115], v[116:119], v[80:83]
  v_mfma_f32_16x16x32_bf16 v[20:23], v[96:99], v[120:123], v[20:23]
  v_mfma_f32_16x16x32_bf16 v[36:39], v[100:103], v[120:123], v[36:39]
  v_mfma_f32_16x16x32_bf16 v[52:55], v[104:107], v[120:123], v[52:55]
  v_mfma_f32_16x16x32_bf16 v[68:71], v[108:111], v[120:123], v[68:71]
  v_mfma_f32_16x16x32_bf16 v[84:87], v[112:115], v[120:123], v[84:87]
  v_mfma_f32_16x16x32_bf16 v[24:27], v[96:99], v[124:127], v[24:27]
  v_mfma_f32_16x16x32_bf16 v[40:43], v[100:103], v[124:127], v[40:43]
  v_mfma_f32_16x16x32_bf16 v[56:59], v[104:107], v[124:127], v[56:59]
  v_mfma_f32_16x16x32_bf16 v[72:75], v[108:111], v[124:127], v[72:75]
  v_mfma_f32_16x16x32_bf16 v[88:91], v[112:115], v[124:127], v[88:91]
  v_mfma_f32_16x16x32_bf16 v[28:31], v[96:99], v[128:131], v[28:31]
  v_mfma_f32_16x16x32_bf16 v[44:47], v[100:103], v[128:131], v[44:47]
  v_mfma_f32_16x16x32_bf16 v[60:63], v[104:107], v[128:131], v[60:63]
  v_mfma_f32_16x16x32_bf16 v[76:79], v[108:111], v[128:131], v[76:79]
  v_mfma_f32_16x16x32_bf16 v[92:95], v[112:115], v[128:131], v[92:95]
  s_waitcnt vmcnt(10)
  v_mfma_f32_16x16x32_bf16 v[16:19], v[132:135], v[152:155], v[16:19]
  v_mfma_f32_16x16x32_bf16 v[32:35], v[136:139], v[152:155], v[32:35]
  v_mfma_f32_16x16x32_bf16 v[48:51], v[140:143], v[152:155], v[48:51]
  v_mfma_f32_16x16x32_bf16 v[64:67], v[144:147], v[152:155], v[64:67]
  v_mfma_f32_16x16x32_bf16 v[80:83], v[148:151], v[152:155], v[80:83]
  v_mfma_f32_16x16x32_bf16 v[20:23], v[132:135], v[156:159], v[20:23]
  v_mfma_f32_16x16x32_bf16 v[36:39], v[136:139], v[156:159], v[36:39]
  v_mfma_f32_16x16x32_bf16 v[52:55], v[140:143], v[156:159], v[52:55]
  v_mfma_f32_16x16x32_bf16 v[68:71], v[144:147], v[156:159], v[68:71]
  v_mfma_f32_16x16x32_bf16 v[84:87], v[148:151], v[156:159], v[84:87]
  v_mfma_f32_16x16x32_bf16 v[24:27], v[132:135], v[160:163], v[24:27]
  v_mfma_f32_16x16x32_bf16 v[40:43], v[136:139], v[160:163], v[40:43]
  v_mfma_f32_16x16x32_bf16 v[56:59], v[140:143], v[160:163], v[56:59]
  v_mfma_f32_16x16x32_bf16 v[72:75], v[144:147], v[160:163], v[72:75]
  v_mfma_f32_16x16x32_bf16 v[88:91], v[148:151], v[160:163], v[88:91]
  v_mfma_f32_16x16x32_bf16 v[28:31], v[132:135], v[164:167], v[28:31]
  v_mfma_f32_16x16x32_bf16 v[44:47], v[136:139], v[164:167], v[44:47]
  v_mfma_f32_16x16x32_bf16 v[60:63], v[140:143], v[164:167], v[60:63]
  v_mfma_f32_16x16x32_bf16 v[76:79], v[144:147], v[164:167], v[76:79]
  v_mfma_f32_16x16x32_bf16 v[92:95], v[148:151], v[164:167], v[92:95]
  s_waitcnt vmcnt(5)
  v_mfma_f32_16x16x32_bf16 v[16:19], v[168:171], v[236:239], v[16:19]
  v_mfma_f32_16x16x32_bf16 v[32:35], v[172:175], v[236:239], v[32:35]
  v_mfma_f32_16x16x32_bf16 v[48:51], v[176:179], v[236:239], v[48:51]
  v_mfma_f32_16x16x32_bf16 v[64:67], v[180:183], v[236:239], v[64:67]
  v_mfma_f32_16x16x32_bf16 v[80:83], v[184:187], v[236:239], v[80:83]
  s_add_u32 s50, s21, 0
  s_and_b32 s50, s50, 3
  s_mul_i32 s50, s50, 5376
  s_mul_i32 s51, s21, 21504
  s_add_u32 s50, s50, s51
  v_add_u32 v232, s50, v230
  s_add_u32 s50, s21, 1
  s_and_b32 s50, s50, 3
  s_mul_i32 s50, s50, 5376
  s_mul_i32 s51, s21, 21504
  s_add_u32 s50, s50, s51
  v_add_u32 v233, s50, v230
  v_mfma_f32_16x16x32_bf16 v[20:23], v[168:171], v[240:243], v[20:23]
  v_mfma_f32_16x16x32_bf16 v[36:39], v[172:175], v[240:243], v[36:39]
  v_mfma_f32_16x16x32_bf16 v[52:55], v[176:179], v[240:243], v[52:55]
  v_mfma_f32_16x16x32_bf16 v[68:71], v[180:183], v[240:243], v[68:71]
  v_mfma_f32_16x16x32_bf16 v[84:87], v[184:187], v[240:243], v[84:87]
  s_add_u32 s50, s21, 2
  s_and_b32 s50, s50, 3
  s_mul_i32 s50, s50, 5376
  s_mul_i32 s51, s21, 21504
  s_add_u32 s50, s50, s51
  v_add_u32 v234, s50, v230
  ds_write_b128 v232, v[16:19] offset:0
  ds_write_b128 v232, v[32:35] offset:64
  ds_write_b128 v232, v[48:51] offset:128
  ds_write_b128 v232, v[64:67] offset:192
  ds_write_b128 v232, v[80:83] offset:256
  v_mfma_f32_16x16x32_bf16 v[24:27], v[168:171], v[244:247], v[24:27]
  v_mfma_f32_16x16x32_bf16 v[40:43], v[172:175], v[244:247], v[40:43]
  v_mfma_f32_16x16x32_bf16 v[56:59], v[176:179], v[244:247], v[56:59]
  v_mfma_f32_16x16x32_bf16 v[72:75], v[180:183], v[244:247], v[72:75]
  v_mfma_f32_16x16x32_bf16 v[88:91], v[184:187], v[244:247], v[88:91]
  s_add_u32 s50, s21, 3
  s_and_b32 s50, s50, 3
  s_mul_i32 s50, s50, 5376
  s_mul_i32 s51, s21, 21504
  s_add_u32 s50, s50, s51
  v_add_u32 v235, s50, v230
  ds_write_b128 v233, v[20:23] offset:0
  ds_write_b128 v233, v[36:39] offset:64
  ds_write_b128 v233, v[52:55] offset:128
  ds_write_b128 v233, v[68:71] offset:192
  ds_write_b128 v233, v[84:87] offset:256
  v_mfma_f32_16x16x32_bf16 v[28:31], v[168:171], v[248:251], v[28:31]
  v_mfma_f32_16x16x32_bf16 v[44:47], v[172:175], v[248:251], v[44:47]
  v_mfma_f32_16x16x32_bf16 v[60:63], v[176:179], v[248:251], v[60:63]
  v_mfma_f32_16x16x32_bf16 v[76:79], v[180:183], v[248:251], v[76:79]
  v_mfma_f32_16x16x32_bf16 v[92:95], v[184:187], v[248:251], v[92:95]
  s_nop 3
  ds_write_b128 v234, v[24:27] offset:0
  ds_write_b128 v234, v[40:43] offset:64
  ds_write_b128 v234, v[56:59] offset:128
  ds_write_b128 v234, v[72:75] offset:192
  ds_write_b128 v234, v[88:91] offset:256
  s_nop 3
  ds_write_b128 v235, v[28:31] offset:0
  ds_write_b128 v235, v[44:47] offset:64
  ds_write_b128 v235, v[60:63] offset:128
  ds_write_b128 v235, v[76:79] offset:192
  ds_write_b128 v235, v[92:95] offset:256
  s_branch L_p2_red
L_p2_hi:
  s_waitcnt vmcnt(18)
  v_mfma_f32_16x16x32_bf16 v[16:19], v[132:135], v[152:155], v[16:19]
  v_mfma_f32_16x16x32_bf16 v[32:35], v[136:139], v[152:155], v[32:35]
  v_mfma_f32_16x16x32_bf16 v[48:51], v[140:143], v[152:155], v[48:51]
  v_mfma_f32_16x16x32_bf16 v[64:67], v[144:147], v[152:155], v[64:67]
  v_mfma_f32_16x16x32_bf16 v[80:83], v[148:151], v[152:155], v[80:83]
  v_mfma_f32_16x16x32_bf16 v[20:23], v[132:135], v[156:159], v[20:23]
  v_mfma_f32_16x16x32_bf16 v[36:39], v[136:139], v[156:159], v[36:39]
  v_mfma_f32_16x16x32_bf16 v[52:55], v[140:143], v[156:159], v[52:55]
  v_mfma_f32_16x16x32_bf16 v[68:71], v[144:147], v[156:159], v[68:71]
  v_mfma_f32_16x16x32_bf16 v[84:87], v[148:151], v[156:159], v[84:87]
  v_mfma_f32_16x16x32_bf16 v[24:27], v[132:135], v[160:163], v[24:27]
  v_mfma_f32_16x16x32_bf16 v[40:43], v[136:139], v[160:163], v[40:43]
  v_mfma_f32_16x16x32_bf16 v[56:59], v[140:143], v[160:163], v[56:59]
  v_mfma_f32_16x16x32_bf16 v[72:75], v[144:147], v[160:163], v[72:75]
  v_mfma_f32_16x16x32_bf16 v[88:91], v[148:151], v[160:163], v[88:91]
  v_mfma_f32_16x16x32_bf16 v[28:31], v[132:135], v[164:167], v[28:31]
  v_mfma_f32_16x16x32_bf16 v[44:47], v[136:139], v[164:167], v[44:47]
  v_mfma_f32_16x16x32_bf16 v[60:63], v[140:143], v[164:167], v[60:63]
  v_mfma_f32_16x16x32_bf16 v[76:79], v[144:147], v[164:167], v[76:79]
  v_mfma_f32_16x16x32_bf16 v[92:95], v[148:151], v[164:167], v[92:95]
  s_waitcnt vmcnt(9)
L_p2_hi2:
  v_cmp_ne_u32 vcc, s75, v214
  v_cmp_ne_u32 s[60:61], s76, v215
  s_nop 3
  s_or_b64 vcc, vcc, s[60:61]
  s_cbranch_vccz L_p2_hi2_ok
  s_sub_u32 s74, s74, 1
  s_cmp_eq_u32 s74, 0
  s_cbranch_scc1 L_p2_hi2_ok
  s_sleep 4
  buffer_load_dwordx2 v[214:215], v12, s[24:27], 0 offen sc1
  s_waitcnt vmcnt(0)
  s_branch L_p2_hi2
L_p2_hi2_ok:
L_p2_hi3:
  v_cmp_ne_u32 vcc, s75, v216
  v_cmp_ne_u32 s[60:61], s76, v217
  s_nop 3
  s_or_b64 vcc, vcc, s[60:61]
  s_cbranch_vccz L_p2_hi3_ok
  s_sub_u32 s74, s74, 1
  s_cmp_eq_u32 s74, 0
  s_cbranch_scc1 L_p2_hi3_ok
  s_sleep 4
  buffer_load_dwordx2 v[216:217], v13, s[24:27], 0 offen sc1
  s_waitcnt vmcnt(0)
  s_branch L_p2_hi3
L_p2_hi3_ok:
  s_mov_b32 s50, s46
  buffer_load_dwordx4 v[132:135], v10, s[24:27], s50 offen sc1
  s_add_u32 s50, s50, s47
  buffer_load_dwordx4 v[136:139], v10, s[24:27], s50 offen sc1
  s_add_u32 s50, s50, s47
  buffer_load_dwordx4 v[140:143], v10, s[24:27], s50 offen sc1
  s_add_u32 s50, s50, s47
  buffer_load_dwordx4 v[144:147], v10, s[24:27], s50 offen sc1
  s_add_u32 s50, s50, s47
  buffer_load_dwordx4 v[148:151], v10, s[24:27], s50 offen sc1
  buffer_load_dwordx2 v[204:205], v225, s[32:35], s38 offen
  buffer_load_dwordx2 v[206:207], v226, s[32:35], s38 offen
  buffer_load_dwordx2 v[208:209], v227, s[32:35], s38 offen
  buffer_load_dwordx2 v[210:211], v228, s[32:35], s38 offen
  buffer_load_dwordx2 v[212:213], v229, s[32:35], s38 offen
  s_waitcnt vmcnt(19)
  v_mfma_f32_16x16x32_bf16 v[16:19], v[168:171], v[188:191], v[16:19]
  v_mfma_f32_16x16x32_bf16 v[32:35], v[172:175], v[188:191], v[32:35]
  v_mfma_f32_16x16x32_bf16 v[48:51], v[176:179], v[188:191], v[48:51]
  v_mfma_f32_16x16x32_bf16 v[64:67], v[180:183], v[188:191], v[64:67]
  v_mfma_f32_16x16x32_bf16 v[80:83], v[184:187], v[188:191], v[80:83]
  v_mfma_f32_16x16x32_bf16 v[20:23], v[168:171], v[192:195], v[20:23]
  v_mfma_f32_16x16x32_bf16 v[36:39], v[172:175], v[192:195], v[36:39]
  v_mfma_f32_16x16x32_bf16 v[52:55], v[176:179], v[192:195], v[52:55]
  v_mfma_f32_16x16x32_bf16 v[68:71], v[180:183], v[192:195], v[68:71]
  v_mfma_f32_16x16x32_bf16 v[84:87], v[184:187], v[192:195], v[84:87]
  v_mfma_f32_16x16x32_bf16 v[24:27], v[168:171], v[196:199], v[24:27]
  v_mfma_f32_16x16x32_bf16 v[40:43], v[172:175], v[196:199], v[40:43]
  v_mfma_f32_16x16x32_bf16 v[56:59], v[176:179], v[196:199], v[56:59]
  v_mfma_f32_16x16x32_bf16 v[72:75], v[180:183], v[196:199], v[72:75]
  v_mfma_f32_16x16x32_bf16 v[88:91], v[184:187], v[196:199], v[88:91]
  v_mfma_f32_16x16x32_bf16 v[28:31], v[168:171], v[200:203], v[28:31]
  v_mfma_f32_16x16x32_bf16 v[44:47], v[172:175], v[200:203], v[44:47]
  v_mfma_f32_16x16x32_bf16 v[60:63], v[176:179], v[200:203], v[60:63]
  v_mfma_f32_16x16x32_bf16 v[76:79], v[180:183], v[200:203], v[76:79]
  v_mfma_f32_16x16x32_bf16 v[92:95], v[184:187], v[200:203], v[92:95]
  s_waitcnt vmcnt(10)
  v_mfma_f32_16x16x32_bf16 v[16:19], v[96:99], v[116:119], v[16:19]
  v_mfma_f32_16x16x32_bf16 v[32:35], v[100:103], v[116:119], v[32:35]
  v_mfma_f32_16x16x32_bf16 v[48:51], v[104:107], v[116:119], v[48:51]
  v_mfma_f32_16x16x32_bf16 v[64:67], v[108:111], v[116:119], v[64:67]
  v_mfma_f32_16x16x32_bf16 v[80:83], v[112:115], v[116:119], v[80:83]
  v_mfma_f32_16x16x32_bf16 v[20:23], v[96:99], v[120:123], v[20:23]
  v_mfma_f32_16x16x32_bf16 v[36:39], v[100:103], v[120:123], v[36:39]
  v_mfma_f32_16x16x32_bf16 v[52:55], v[104:107], v[120:123], v[52:55]
  v_mfma_f32_16x16x32_bf16 v[68:71], v[108:111], v[120:123], v[68:71]
  v_mfma_f32_16x16x32_bf16 v[84:87], v[112:115], v[120:123], v[84:87]
  v_mfma_f32_16x16x32_bf16 v[24:27], v[96:99], v[124:127], v[24:27]
  v_mfma_f32_16x16x32_bf16 v[40:43], v[100:103], v[124:127], v[40:43]
  v_mfma_f32_16x16x32_bf16 v[56:59], v[104:107], v[124:127], v[56:59]
  v_mfma_f32_16x16x32_bf16 v[72:75], v[108:111], v[124:127], v[72:75]
  v_mfma_f32_16x16x32_bf16 v[88:91], v[112:115], v[124:127], v[88:91]
  v_mfma_f32_16x16x32_bf16 v[28:31], v[96:99], v[128:131], v[28:31]
  v_mfma_f32_16x16x32_bf16 v[44:47], v[100:103], v[128:131], v[44:47]
  v_mfma_f32_16x16x32_bf16 v[60:63], v[104:107], v[128:131], v[60:63]
  v_mfma_f32_16x16x32_bf16 v[76:79], v[108:111], v[128:131], v[76:79]
  v_mfma_f32_16x16x32_bf16 v[92:95], v[112:115], v[128:131], v[92:95]
  s_waitcnt vmcnt(5)
  v_mfma_f32_16x16x32_bf16 v[16:19], v[132:135], v[236:239], v[16:19]
  v_mfma_f32_16x16x32_bf16 v[32:35], v[136:139], v[236:239], v[32:35]
  v_mfma_f32_16x16x32_bf16 v[48:51], v[140:143], v[236:239], v[48:51]
  v_mfma_f32_16x16x32_bf16 v[64:67], v[144:147], v[236:239], v[64:67]
  v_mfma_f32_16x16x32_bf16 v[80:83], v[148:151], v[236:239], v[80:83]
  s_add_u32 s50, s21, 0
  s_and_b32 s50, s50, 3
  s_mul_i32 s50, s50, 5376
  s_mul_i32 s51, s21, 21504
  s_add_u32 s50, s50, s51
  v_add_u32 v232, s50, v230
  s_add_u32 s50, s21, 1
  s_and_b32 s50, s50, 3
  s_mul_i32 s50, s50, 5376
  s_mul_i32 s51, s21, 21504
  s_add_u32 s50, s50, s51
  v_add_u32 v233, s50, v230
  v_mfma_f32_16x16x32_bf16 v[20:23], v[132:135], v[240:243], v[20:23]
  v_mfma_f32_16x16x32_bf16 v[36:39], v[136:139], v[240:243], v[36:39]
  v_mfma_f32_16x16x32_bf16 v[52:55], v[140:143], v[240:243], v[52:55]
  v_mfma_f32_16x16x32_bf16 v[68:71], v[144:147], v[240:243], v[68:71]
  v_mfma_f32_16x16x32_bf16 v[84:87], v[148:151], v[240:243], v[84:87]
  s_add_u32 s50, s21, 2
  s_and_b32 s50, s50, 3
  s_mul_i32 s50, s50, 5376
  s_mul_i32 s51, s21, 21504
  s_add_u32 s50, s50, s51
  v_add_u32 v234, s50, v230
  ds_write_b128 v232, v[16:19] offset:0
  ds_write_b128 v232, v[32:35] offset:64
  ds_write_b128 v232, v[48:51] offset:128
  ds_write_b128 v232, v[64:67] offset:192
  ds_write_b128 v232, v[80:83] offset:256
  v_mfma_f32_16x16x32_bf16 v[24:27], v[132:135], v[244:247], v[24:27]
  v_mfma_f32_16x16x32_bf16 v[40:43], v[136:139], v[244:247], v[40:43]
  v_mfma_f32_16x16x32_bf16 v[56:59], v[140:143], v[244:247], v[56:59]
  v_mfma_f32_16x16x32_bf16 v[72:75], v[144:147], v[244:247], v[72:75]
  v_mfma_f32_16x16x32_bf16 v[88:91], v[148:151], v[244:247], v[88:91]
  s_add_u32 s50, s21, 3
  s_and_b32 s50, s50, 3
  s_mul_i32 s50, s50, 5376
  s_mul_i32 s51, s21, 21504
  s_add_u32 s50, s50, s51
  v_add_u32 v235, s50, v230
  ds_write_b128 v233, v[20:23] offset:0
  ds_write_b128 v233, v[36:39] offset:64
  ds_write_b128 v233, v[52:55] offset:128
  ds_write_b128 v233, v[68:71] offset:192
  ds_write_b128 v233, v[84:87] offset:256
  v_mfma_f32_16x16x32_bf16 v[28:31], v[132:135], v[248:251], v[28:31]
  v_mfma_f32_16x16x32_bf16 v[44:47], v[136:139], v[248:251], v[44:47]
  v_mfma_f32_16x16x32_bf16 v[60:63], v[140:143], v[248:251], v[60:63]
  v_mfma_f32_16x16x32_bf16 v[76:79], v[144:147], v[248:251], v[76:79]
  v_mfma_f32_16x16x32_bf16 v[92:95], v[148:151], v[248:251], v[92:95]
  s_nop 3
  ds_write_b128 v234, v[24:27] offset:0
  ds_write_b128 v234, v[40:43] offset:64
  ds_write_b128 v234, v[56:59] offset:128
  ds_write_b128 v234, v[72:75] offset:192
  ds_write_b128 v234, v[88:91] offset:256
  s_nop 3
  ds_write_b128 v235, v[28:31] offset:0
  ds_write_b128 v235, v[44:47] offset:64
  ds_write_b128 v235, v[60:63] offset:128
  ds_write_b128 v235, v[76:79] offset:192
  ds_write_b128 v235, v[92:95] offset:256
L_p2_red:
  s_waitcnt lgkmcnt(0)
  s_barrier
  ds_read_b128 v[96:99], v220 offset:0
  ds_read_b128 v[100:103], v220 offset:21504
  ds_read_b128 v[104:107], v220 offset:43008
  ds_read_b128 v[108:111], v220 offset:64512
  ds_read_b128 v[112:115], v221 offset:0
  ds_read_b128 v[116:119], v221 offset:21504
  ds_read_b128 v[120:123], v221 offset:43008
  ds_read_b128 v[124:127], v221 offset:64512
  ds_read_b128 v[128:131], v222 offset:0
  ds_read_b128 v[132:135], v222 offset:21504
  ds_read_b128 v[136:139], v222 offset:43008
  ds_read_b128 v[140:143], v222 offset:64512
  s_waitcnt vmcnt(0) lgkmcnt(8)
  v_pk_add_f32 v[96:97], v[96:97], v[100:101]
  v_pk_add_f32 v[98:99], v[98:99], v[102:103]
  v_pk_add_f32 v[104:105], v[104:105], v[108:109]
  v_pk_add_f32 v[106:107], v[106:107], v[110:111]
  v_lshlrev_b32 v100, 16, v204
  v_and_b32 v101, 0xffff0000, v204
  v_lshlrev_b32 v102, 16, v205
  v_and_b32 v103, 0xffff0000, v205
  v_pk_add_f32 v[96:97], v[96:97], v[104:105]
  v_pk_add_f32 v[98:99], v[98:99], v[106:107]
  v_pk_add_f32 v[96:97], v[96:97], v[100:101]
  v_pk_add_f32 v[98:99], v[98:99], v[102:103]
  v_cvt_pk_bf16_f32 v204, v96, v97
  v_cvt_pk_bf16_f32 v205, v98, v99
  buffer_store_dwordx2 v[204:205], v225, s[40:43], s38 offen
  ds_read_b128 v[144:147], v223 offset:0
  ds_read_b128 v[148:151], v223 offset:21504
  ds_read_b128 v[152:155], v223 offset:43008
  ds_read_b128 v[156:159], v223 offset:64512
  s_waitcnt lgkmcnt(8)
  v_pk_add_f32 v[112:113], v[112:113], v[116:117]
  v_pk_add_f32 v[114:115], v[114:115], v[118:119]
  v_pk_add_f32 v[120:121], v[120:121], v[124:125]
  v_pk_add_f32 v[122:123], v[122:123], v[126:127]
  v_lshlrev_b32 v116, 16, v206
  v_and_b32 v117, 0xffff0000, v206
  v_lshlrev_b32 v118, 16, v207
  v_and_b32 v119, 0xffff0000, v207
  v_pk_add_f32 v[112:113], v[112:113], v[120:121]
  v_pk_add_f32 v[114:115], v[114:115], v[122:123]
  v_pk_add_f32 v[112:113], v[112:113], v[116:117]
  v_pk_add_f32 v[114:115], v[114:115], v[118:119]
  v_cvt_pk_bf16_f32 v206, v112, v113
  v_cvt_pk_bf16_f32 v207, v114, v115
  buffer_store_dwordx2 v[206:207], v226, s[40:43], s38 offen
  ds_read_b128 v[160:163], v224 offset:0
  ds_read_b128 v[164:167], v224 offset:21504
  ds_read_b128 v[168:171], v224 offset:43008
  ds_read_b128 v[172:175], v224 offset:64512
  s_waitcnt lgkmcnt(8)
  v_pk_add_f32 v[128:129], v[128:129], v[132:133]
  v_pk_add_f32 v[130:131], v[130:131], v[134:135]
  v_pk_add_f32 v[136:137], v[136:137], v[140:141]
  v_pk_add_f32 v[138:139], v[138:139], v[142:143]
  v_lshlrev_b32 v132, 16, v208
  v_and_b32 v133, 0xffff0000, v208
  v_lshlrev_b32 v134, 16, v209
  v_and_b32 v135, 0xffff0000, v209
  v_pk_add_f32 v[128:129], v[128:129], v[136:137]
  v_pk_add_f32 v[130:131], v[130:131], v[138:139]
  v_pk_add_f32 v[128:129], v[128:129], v[132:133]
  v_pk_add_f32 v[130:131], v[130:131], v[134:135]
  v_cvt_pk_bf16_f32 v208, v128, v129
  v_cvt_pk_bf16_f32 v209, v130, v131
  buffer_store_dwordx2 v[208:209], v227, s[40:43], s38 offen
  s_waitcnt lgkmcnt(4)
  v_pk_add_f32 v[144:145], v[144:145], v[148:149]
  v_pk_add_f32 v[146:147], v[146:147], v[150:151]
  v_pk_add_f32 v[152:153], v[152:153], v[156:157]
  v_pk_add_f32 v[154:155], v[154:155], v[158:159]
  v_lshlrev_b32 v148, 16, v210
  v_and_b32 v149, 0xffff0000, v210
  v_lshlrev_b32 v150, 16, v211
  v_and_b32 v151, 0xffff0000, v211
  v_pk_add_f32 v[144:145], v[144:145], v[152:153]
  v_pk_add_f32 v[146:147], v[146:147], v[154:155]
  v_pk_add_f32 v[144:145], v[144:145], v[148:149]
  v_pk_add_f32 v[146:147], v[146:147], v[150:151]
  v_cvt_pk_bf16_f32 v210, v144, v145
  v_cvt_pk_bf16_f32 v211, v146, v147
  buffer_store_dwordx2 v[210:211], v228, s[40:43], s38 offen
  s_waitcnt lgkmcnt(0)
  v_pk_add_f32 v[160:161], v[160:161], v[164:165]
  v_pk_add_f32 v[162:163], v[162:163], v[166:167]
  v_pk_add_f32 v[168:169], v[168:169], v[172:173]
  v_pk_add_f32 v[170:171], v[170:171], v[174:175]
  v_lshlrev_b32 v164, 16, v212
  v_and_b32 v165, 0xffff0000, v212
  v_lshlrev_b32 v166, 16, v213
  v_and_b32 v167, 0xffff0000, v213
  v_pk_add_f32 v[160:161], v[160:161], v[168:169]
  v_pk_add_f32 v[162:163], v[162:163], v[170:171]
  v_pk_add_f32 v[160:161], v[160:161], v[164:165]
  v_pk_add_f32 v[162:163], v[162:163], v[166:167]
  v_cvt_pk_bf16_f32 v212, v160, v161
  v_cvt_pk_bf16_f32 v213, v162, v163
  buffer_store_dwordx2 v[212:213], v229, s[40:43], s38 offen
  s_endpgm
L_end:
  s_endpgm
L_code_end:
.section .rodata,"a"
.p2align 6
.amdhsa_kernel parallel_sum__spectral_fnet__dense_activation_relu__prompt_kernel
    .amdhsa_next_free_vgpr 256
    .amdhsa_next_free_sgpr 102
    .amdhsa_accum_offset 256
    .amdhsa_group_segment_fixed_size 0
    .amdhsa_kernarg_size 88
    .amdhsa_user_sgpr_count 2
    .amdhsa_user_sgpr_kernarg_segment_ptr 1
    .amdhsa_system_sgpr_workgroup_id_x 1
.end_amdhsa_kernel
```
